```python
import torch

def _softmax(x, axis=-1):
    return torch.softmax(x, dim=axis)
def _gelu(x):
    return torch.nn.functional.gelu(x, approximate="tanh")
def _silu(x):
    return torch.nn.functional.silu(x)
def _sigmoid(x):
    return torch.sigmoid(x)
def _layernorm(x, axis=-1, eps=1e-5):
    m = x.mean(dim=axis, keepdim=True)
    v = x.var(dim=axis, keepdim=True, unbiased=False)
    return (x - m) / torch.sqrt(v + eps)
def _scatter_add(tgt, idx, src, axis=0):
    return tgt.clone().index_add_(axis, idx, src)
def _segment_sum(src, seg, n):
    out = torch.zeros((n,) + src.shape[1:], dtype=src.dtype)
    return out.index_add_(0, seg, src)
def _pad(x, pw):
    flat = tuple(v for pair in reversed(pw) for v in pair)
    return torch.nn.functional.pad(x, flat)

kernel_name = 'concat_heads__gqa_block_cached__gqa_block_cached__near_ridge'

def setup_inputs():

    _w = (lambda a: (lambda t: t.to(torch.bfloat16) if t.is_floating_point() else t)(torch.as_tensor(a)))
    def _A_setup():
        B, Sq, D = 16, 32, 1024
        Hq, Hkv, Sk, Dh = 32, 4, 512, 128
        assert Hq % Hkv == 0, (Hq, Hkv)
        return {
            "x": _w((lambda *s: torch.randn(*s, dtype=torch.bfloat16) * 0.8)(B, Sq, D)),
            "k_cache": _w((lambda *s: torch.randn(*s, dtype=torch.bfloat16) * 0.8)(B, Hkv, Sk, Dh)),
            "v_cache": _w((lambda *s: torch.randn(*s, dtype=torch.bfloat16) * 0.05)(B, Hkv, Sk, Dh)),
            "wq": _w((lambda *s: torch.randn(*s, dtype=torch.bfloat16) * 0.8)(D, Hq * Dh) * (D ** -0.5)),
            "wo": _w((lambda *s: torch.randn(*s, dtype=torch.bfloat16) * 0.05)(Hq * Dh, D) * ((Hq * Dh) ** -0.5)),
        }
    _A_in = _A_setup()

    def _B_setup():
        B, Sq, D = 16, 32, 1024
        Hq, Hkv, Sk, Dh = 32, 4, 512, 128
        assert Hq % Hkv == 0, (Hq, Hkv)
        return {
            "x": _w((lambda *s: torch.randn(*s, dtype=torch.bfloat16) * 0.8)(B, Sq, D)),
            "k_cache": _w((lambda *s: torch.randn(*s, dtype=torch.bfloat16) * 0.8)(B, Hkv, Sk, Dh)),
            "v_cache": _w((lambda *s: torch.randn(*s, dtype=torch.bfloat16) * 0.05)(B, Hkv, Sk, Dh)),
            "wq": _w((lambda *s: torch.randn(*s, dtype=torch.bfloat16) * 0.8)(D, Hq * Dh) * (D ** -0.5)),
            "wo": _w((lambda *s: torch.randn(*s, dtype=torch.bfloat16) * 0.05)(Hq * Dh, D) * ((Hq * Dh) ** -0.5)),
        }
    _B_in = _B_setup()

    return {
        "A_x": _A_in["x"],
        "A_k_cache": _A_in["k_cache"],
        "A_v_cache": _A_in["v_cache"],
        "A_wq": _A_in["wq"],
        "A_wo": _A_in["wo"],
        "B_x": _B_in["x"],
        "B_k_cache": _B_in["k_cache"],
        "B_v_cache": _B_in["v_cache"],
        "B_wq": _B_in["wq"],
        "B_wo": _B_in["wo"],
    }

def reference(A_x, A_k_cache, A_v_cache, A_wq, A_wo, B_x, B_k_cache, B_v_cache, B_wq, B_wo):
    def _A_ref(x, k_cache, v_cache, wq, wo):
        B, Sq, D = x.shape
        Hq, Dh = 32, 128
        Hkv = k_cache.shape[1]
        rep = Hq // Hkv
        q = (lambda x, *d: x.permute(*d))((x @ wq).reshape(B, Sq, Hq, Dh), 0, 2, 1, 3)
        k = (lambda x, n, axis: torch.repeat_interleave(x, n, dim=axis))(k_cache, rep, axis=1)
        v = (lambda x, n, axis: torch.repeat_interleave(x, n, dim=axis))(v_cache, rep, axis=1)
        scores = torch.einsum("bhqd,bhkd->bhqk", q, k) * (Dh ** -0.5)
        p = _softmax(scores, axis=-1)
        o = torch.einsum("bhqk,bhkd->bhqd", p, v)
        return (lambda x, *d: x.permute(*d))(o, 0, 2, 1, 3).reshape(B, Sq, Hq * Dh) @ wo

    def _B_ref(x, k_cache, v_cache, wq, wo):
        B, Sq, D = x.shape
        Hq, Dh = 32, 128
        Hkv = k_cache.shape[1]
        rep = Hq // Hkv
        q = (lambda x, *d: x.permute(*d))((x @ wq).reshape(B, Sq, Hq, Dh), 0, 2, 1, 3)
        k = (lambda x, n, axis: torch.repeat_interleave(x, n, dim=axis))(k_cache, rep, axis=1)
        v = (lambda x, n, axis: torch.repeat_interleave(x, n, dim=axis))(v_cache, rep, axis=1)
        scores = torch.einsum("bhqd,bhkd->bhqk", q, k) * (Dh ** -0.5)
        p = _softmax(scores, axis=-1)
        o = torch.einsum("bhqk,bhkd->bhqd", p, v)
        return (lambda x, *d: x.permute(*d))(o, 0, 2, 1, 3).reshape(B, Sq, Hq * Dh) @ wo

    a = _A_ref(A_x, A_k_cache, A_v_cache, A_wq, A_wo)
    b = _B_ref(B_x, B_k_cache, B_v_cache, B_wq, B_wo)
    return torch.concatenate([a, b], axis=-1)
```

```asm
; @launch grid=(256,1,1) block=(512,1,1) lds=163840
.amdgcn_target "amdgcn-amd-amdhsa--gfx950"
.text
.globl concat_heads__gqa_block_cached__gqa_block_cached__near_ridge_kernel
.p2align 12
.p2align 8
.type concat_heads__gqa_block_cached__gqa_block_cached__near_ridge_kernel,@function
concat_heads__gqa_block_cached__gqa_block_cached__near_ridge_kernel:
    s_cmp_ge_u32 s2, 256
    s_cbranch_scc1 L_end
    s_load_dwordx16 s[16:31], s[0:1], 0
    s_load_dwordx8 s[32:39], s[0:1], 64
    s_load_dwordx2 s[40:41], s[0:1], 96
    v_lshrrev_b32 v1, 6, v0
    v_and_b32 v0, 63, v0
    s_bfe_u32 s3, s2, 0x10002
    s_and_b32 s4, s2, 3
    v_readfirstlane_b32 s7, v1
    s_bfe_u32 s6, s2, 0x20003
    s_lshr_b32 s5, s2, 5
    s_add_u32 s42, s5, s6
    s_and_b32 s42, s42, 3
    s_cmp_lg_u32 s7, 7
    s_cbranch_scc1 L_nopf
    s_getpc_b64 s[44:45]
L_pcref:
    s_sub_u32 s44, s44, L_pcref-concat_heads__gqa_block_cached__gqa_block_cached__near_ridge_kernel
    s_subb_u32 s45, s45, 0
    s_lshr_b32 s46, s2, 3
    s_lshl_b32 s46, s46, 11
    v_lshl_add_u32 v2, v0, 7, s46
    v_min_u32 v2, L_codeend-concat_heads__gqa_block_cached__gqa_block_cached__near_ridge_kernel-4, v2
    s_mov_b64 exec, 0xffff
    global_load_dword v27, v2, s[44:45]
    s_mov_b64 exec, -1
L_nopf:
    s_cmp_lt_u32 s7, 4
    s_cbranch_scc1 L_cons
    s_setprio 3
    s_sub_u32 s8, s7, 4
    s_and_b32 s9, s8, 1
    v_lshrrev_b32 v10, 5, v0
    s_lshl_b32 s10, s9, 2
    s_and_b32 s11, s5, 4
    s_lshl_b32 s11, s11, 1
    s_or_b32 s10, s10, s11
    v_lshl_add_u32 v11, v10, 1, s10
    v_and_b32 v12, 31, v0
    v_xor_b32 v12, v12, v11
    v_lshlrev_b32 v12, 4, v12
    v_lshl_add_u32 v20, v10, 13, v12
    v_xor_b32 v19, 0x80, v20
    v_lshrrev_b32 v10, 4, v0
    s_lshl_b32 s10, s9, 2
    v_add_u32 v11, s10, v10
    v_and_b32 v12, 7, v0
    v_xor_b32 v11, v12, v11
    v_lshlrev_b32 v11, 4, v11
    v_lshrrev_b32 v13, 3, v0
    v_lshl_add_u32 v21, v13, 11, v11
    s_lshl_b32 s13, s8, 14
    s_lshl_b32 s10, s4, 11
    s_add_u32 s13, s13, s10
    s_lshl_b32 s10, s6, 9
    s_add_u32 s13, s13, s10
    s_lshl_b32 s14, s5, 17
    s_lshl_b32 s10, s8, 14
    s_add_u32 s14, s14, s10
    s_mov_b32 s98, 0xc5382140
    s_mov_b32 s99, 0xfedba976
    s_cmp_eq_u32 s42, 1
    s_cselect_b32 s98, 0x64932501, s98
    s_cselect_b32 s99, 0xfecba87d, s99
    s_cmp_eq_u32 s42, 2
    s_cselect_b32 s98, 0x5a436102, s98
    s_cselect_b32 s99, 0xfdcb98e7, s99
    s_cmp_eq_u32 s42, 3
    s_cselect_b32 s98, 0xb5472103, s98
    s_cselect_b32 s99, 0xedca9f86, s99
    s_lshl_b32 s9, s8, 10
    s_mov_b32 s11, s9
    s_mov_b32 s101, 65536
    s_mov_b32 s87, 4096
    s_cmp_lt_u32 s5, 4
    s_cbranch_scc1 L_norev
    s_add_u32 s11, s11, 28672
    s_add_u32 s13, s13, 458752
    s_mov_b32 s101, -65536
    s_mov_b32 s87, -4096
L_norev:
    s_waitcnt lgkmcnt(0)
    s_cmp_eq_u32 s3, 0
    s_cselect_b32 s44, s16, s26
    s_cselect_b32 s45, s17, s27
    s_mov_b32 s46, 1048576
    s_mov_b32 s47, 0x20000
    s_cselect_b32 s48, s22, s32
    s_cselect_b32 s49, s23, s33
    s_mov_b32 s50, 8388608
    s_mov_b32 s51, 0x20000
    s_bfe_u32 s100, s98, 0x40000
    s_lshl_b32 s84, s100, 7
    s_add_u32 s84, s84, s14
    s_add_u32 m0, s9, 155648
    s_nop 0
    buffer_load_dwordx4 v21, s[44:47], s84 offen  lds
    s_add_u32 m0, s9, 159744
    s_add_u32 s84, s84, 65536
    buffer_load_dwordx4 v21, s[44:47], s84 offen  lds
    s_lshl_b32 s84, s100, 19
    s_add_u32 m0, s11, 122880
    s_add_u32 s84, s84, s13
    buffer_load_dwordx4 v20, s[48:51], s84 offen  lds
    s_add_u32 m0, m0, s87
    s_add_u32 s84, s84, s101
    buffer_load_dwordx4 v19, s[48:51], s84 offen  lds
    s_add_u32 m0, m0, s87
    s_add_u32 s84, s84, s101
    buffer_load_dwordx4 v20, s[48:51], s84 offen  lds
    s_add_u32 m0, m0, s87
    s_add_u32 s84, s84, s101
    buffer_load_dwordx4 v19, s[48:51], s84 offen  lds
    s_add_u32 m0, m0, s87
    s_add_u32 s84, s84, s101
    buffer_load_dwordx4 v20, s[48:51], s84 offen  lds
    s_add_u32 m0, m0, s87
    s_add_u32 s84, s84, s101
    buffer_load_dwordx4 v19, s[48:51], s84 offen  lds
    s_mov_b32 s89, s84
    v_lshrrev_b32 v10, 4, v0
    v_and_b32 v11, 15, v0
    v_xor_b32 v11, v11, v10
    v_lshlrev_b32 v11, 4, v11
    v_lshl_add_u32 v22, v10, 8, v11
    v_lshlrev_b32 v23, 4, v0
    s_lshl_b32 s15, s5, 20
    s_lshl_b32 s10, s4, 17
    s_add_u32 s15, s15, s10
    s_cmp_eq_u32 s3, 0
    s_cselect_b32 s52, s18, s28
    s_cselect_b32 s53, s19, s29
    s_mov_b32 s54, 8388608
    s_mov_b32 s55, 0x20000
    s_cselect_b32 s56, s20, s30
    s_cselect_b32 s57, s21, s31
    s_mov_b32 s58, 8388608
    s_mov_b32 s59, 0x20000
    s_cselect_b32 s60, s24, s34
    s_cselect_b32 s61, s25, s35
    s_mov_b32 s62, 8388608
    s_mov_b32 s63, 0x20000
    s_mov_b32 s82, 0x65832140
    s_mov_b32 s83, 0xfedba9c7
    s_cmp_eq_u32 s42, 1
    s_cselect_b32 s82, 0x69432501, s82
    s_cselect_b32 s83, 0xfecbad87, s83
    s_cmp_eq_u32 s42, 2
    s_cselect_b32 s82, 0xa5436102, s82
    s_cselect_b32 s83, 0xfdcbe987, s83
    s_cmp_eq_u32 s42, 3
    s_cselect_b32 s82, 0x65472103, s82
    s_cselect_b32 s83, 0xedcfa98b, s83
    v_lshlrev_b32 v24, 7, v0
    v_lshlrev_b32 v25, 11, v0
    s_and_b32 s16, s82, 15
    s_lshl_b32 s16, s16, 13
    s_add_u32 s16, s16, s15
    s_and_b32 s10, s8, 1
    s_lshl_b32 s10, s10, 19
    s_add_u32 s16, s16, s10
    s_lshl_b32 s17, s5, 19
    s_lshl_b32 s10, s8, 17
    s_add_u32 s17, s17, s10
    s_lshl_b32 s10, s4, 9
    s_add_u32 s17, s17, s10
    s_lshl_b32 s10, s6, 7
    s_add_u32 s17, s17, s10
    s_lshl_b32 s10, s8, 11
    s_add_u32 s15, s15, s10
    s_mul_i32 s12, s8, 2176
    s_mov_b32 s64, s40
    s_mov_b32 s65, s41
    s_mov_b32 s66, 11534336
    s_mov_b32 s67, 0x20000
    s_mov_b32 s68, s36
    s_mov_b32 s69, s37
    s_mov_b32 s70, 2097152
    s_mov_b32 s71, 0x20000
    s_mov_b32 s72, s38
    s_mov_b32 s73, s39
    s_mov_b32 s74, 256
    s_mov_b32 s75, 0x20000
    s_lshl_b32 s43, s3, 3
    s_add_u32 s43, s43, s5
    s_lshl_b32 s88, s43, 11
    s_add_u32 s88, s88, 8388608
    v_lshrrev_b32 v2, 5, v0
    v_bfe_u32 v3, v0, 2, 2
    v_and_b32 v4, 3, v0
    v_bfe_u32 v5, v0, 4, 1
    v_and_b32 v6, 31, v0
    s_and_b32 s84, s7, 3
    s_mul_i32 s76, s84, 10240
    v_lshl_add_u32 v8, v5, 2, v3
    v_lshrrev_b32 v9, 1, v8
    v_lshlrev_b32 v8, 7, v8
    v_lshl_add_u32 v8, v9, 5, v8
    v_lshl_add_u32 v8, v4, 3, v8
    v_mul_u32_u24 v9, 40960, v2
    v_add3_u32 v8, v8, v9, s76
    v_and_b32 v9, 15, v0
    v_lshl_add_u32 v9, v5, 5, v9
    v_lshlrev_b32 v9, 4, v9
    v_lshl_add_u32 v6, v2, 13, v9
    v_and_b32 v9, 7, v0
    v_lshrrev_b32 v10, 4, v0
    v_lshlrev_b32 v10, 1, v10
    v_xor_b32 v9, v9, v10
    v_lshlrev_b32 v9, 4, v9
    v_lshrrev_b32 v10, 3, v0
    v_lshl_add_u32 v5, v10, 11, v9
    v_xor_b32 v1, 0, v8
    v_xor_b32 v2, 32, v8
    v_xor_b32 v3, 64, v8
    v_xor_b32 v4, 96, v8
    s_and_b32 s85, s5, 1
    s_lshl_b32 s85, s85, 2
    s_xor_b32 s85, s85, s7
    s_lshr_b32 s86, s5, 1
    s_add_u32 s86, s86, s6
    s_and_b32 s86, s86, 3
    s_lshl_b32 s78, s85, 15
    s_lshl_b32 s84, s4, 9
    s_add_u32 s78, s78, s84
    s_lshl_b32 s84, s6, 7
    s_add_u32 s78, s78, s84
    s_lshl_b32 s79, s43, 19
    s_lshl_b32 s84, s85, 10
    s_add_u32 s79, s79, s84
    s_mov_b32 s80, 0x76543210
    s_mov_b32 s81, 0xfedcba98
    s_cmp_eq_u32 s86, 1
    s_cselect_b32 s80, 0x47650321, s80
    s_cselect_b32 s81, 0xcfed8ba9, s81
    s_cmp_eq_u32 s86, 2
    s_cselect_b32 s80, 0x54761032, s80
    s_cselect_b32 s81, 0xdcfe98ba, s81
    s_cmp_eq_u32 s86, 3
    s_cselect_b32 s80, 0x65472103, s80
    s_cselect_b32 s81, 0xedcfa98b, s81
    s_mov_b32 s84, s89
    s_add_u32 m0, m0, s87
    s_add_u32 s84, s84, s101
    buffer_load_dwordx4 v20, s[48:51], s84 offen  lds
    s_add_u32 m0, m0, s87
    s_add_u32 s84, s84, s101
    buffer_load_dwordx4 v19, s[48:51], s84 offen  lds
    s_bfe_u32 s100, s98, 0x40004
    s_lshl_b32 s84, s100, 7
    s_add_u32 s84, s84, s14
    s_add_u32 m0, s9, 32768
    s_nop 0
    buffer_load_dwordx4 v21, s[44:47], s84 offen  lds
    s_add_u32 m0, s9, 36864
    s_add_u32 s84, s84, 65536
    buffer_load_dwordx4 v21, s[44:47], s84 offen  lds
    s_lshl_b32 s84, s100, 19
    s_add_u32 m0, s11, 0
    s_add_u32 s84, s84, s13
    buffer_load_dwordx4 v20, s[48:51], s84 offen  lds
    s_add_u32 m0, m0, s87
    s_add_u32 s84, s84, s101
    buffer_load_dwordx4 v19, s[48:51], s84 offen  lds
    s_add_u32 m0, m0, s87
    s_add_u32 s84, s84, s101
    buffer_load_dwordx4 v20, s[48:51], s84 offen  lds
    s_add_u32 m0, m0, s87
    s_add_u32 s84, s84, s101
    buffer_load_dwordx4 v19, s[48:51], s84 offen  lds
    s_add_u32 m0, m0, s87
    s_add_u32 s84, s84, s101
    buffer_load_dwordx4 v20, s[48:51], s84 offen  lds
    s_add_u32 m0, m0, s87
    s_add_u32 s84, s84, s101
    buffer_load_dwordx4 v19, s[48:51], s84 offen  lds
    s_add_u32 m0, m0, s87
    s_add_u32 s84, s84, s101
    buffer_load_dwordx4 v20, s[48:51], s84 offen  lds
    s_add_u32 m0, m0, s87
    s_add_u32 s84, s84, s101
    buffer_load_dwordx4 v19, s[48:51], s84 offen  lds
    s_waitcnt vmcnt(10)
    s_barrier
    s_bfe_u32 s100, s98, 0x40008
    s_lshl_b32 s84, s100, 7
    s_add_u32 s84, s84, s14
    s_add_u32 m0, s9, 73728
    s_nop 0
    buffer_load_dwordx4 v21, s[44:47], s84 offen  lds
    s_add_u32 m0, s9, 77824
    s_add_u32 s84, s84, 65536
    buffer_load_dwordx4 v21, s[44:47], s84 offen  lds
    s_lshl_b32 s84, s100, 19
    s_add_u32 m0, s11, 40960
    s_add_u32 s84, s84, s13
    buffer_load_dwordx4 v20, s[48:51], s84 offen  lds
    s_add_u32 m0, m0, s87
    s_add_u32 s84, s84, s101
    buffer_load_dwordx4 v19, s[48:51], s84 offen  lds
    s_add_u32 m0, m0, s87
    s_add_u32 s84, s84, s101
    buffer_load_dwordx4 v20, s[48:51], s84 offen  lds
    s_add_u32 m0, m0, s87
    s_add_u32 s84, s84, s101
    buffer_load_dwordx4 v19, s[48:51], s84 offen  lds
    s_add_u32 m0, m0, s87
    s_add_u32 s84, s84, s101
    buffer_load_dwordx4 v20, s[48:51], s84 offen  lds
    s_add_u32 m0, m0, s87
    s_add_u32 s84, s84, s101
    buffer_load_dwordx4 v19, s[48:51], s84 offen  lds
    s_add_u32 m0, m0, s87
    s_add_u32 s84, s84, s101
    buffer_load_dwordx4 v20, s[48:51], s84 offen  lds
    s_add_u32 m0, m0, s87
    s_add_u32 s84, s84, s101
    buffer_load_dwordx4 v19, s[48:51], s84 offen  lds
    s_bfe_u32 s100, s98, 0x4000c
    s_lshl_b32 s84, s100, 7
    s_add_u32 s84, s84, s14
    s_add_u32 m0, s9, 114688
    s_nop 0
    buffer_load_dwordx4 v21, s[44:47], s84 offen  lds
    s_add_u32 m0, s9, 118784
    s_add_u32 s84, s84, 65536
    buffer_load_dwordx4 v21, s[44:47], s84 offen  lds
    s_lshl_b32 s84, s100, 19
    s_add_u32 m0, s11, 81920
    s_add_u32 s84, s84, s13
    buffer_load_dwordx4 v20, s[48:51], s84 offen  lds
    s_add_u32 m0, m0, s87
    s_add_u32 s84, s84, s101
    buffer_load_dwordx4 v19, s[48:51], s84 offen  lds
    s_add_u32 m0, m0, s87
    s_add_u32 s84, s84, s101
    buffer_load_dwordx4 v20, s[48:51], s84 offen  lds
    s_add_u32 m0, m0, s87
    s_add_u32 s84, s84, s101
    buffer_load_dwordx4 v19, s[48:51], s84 offen  lds
    s_add_u32 m0, m0, s87
    s_add_u32 s84, s84, s101
    buffer_load_dwordx4 v20, s[48:51], s84 offen  lds
    s_add_u32 m0, m0, s87
    s_add_u32 s84, s84, s101
    buffer_load_dwordx4 v19, s[48:51], s84 offen  lds
    s_add_u32 m0, m0, s87
    s_add_u32 s84, s84, s101
    buffer_load_dwordx4 v20, s[48:51], s84 offen  lds
    s_add_u32 m0, m0, s87
    s_add_u32 s84, s84, s101
    buffer_load_dwordx4 v19, s[48:51], s84 offen  lds
    s_waitcnt vmcnt(20)
    s_barrier
    s_bfe_u32 s100, s98, 0x40010
    s_lshl_b32 s84, s100, 7
    s_add_u32 s84, s84, s14
    s_add_u32 m0, s9, 155648
    s_nop 0
    buffer_load_dwordx4 v21, s[44:47], s84 offen  lds
    s_add_u32 m0, s9, 159744
    s_add_u32 s84, s84, 65536
    buffer_load_dwordx4 v21, s[44:47], s84 offen  lds
    s_lshl_b32 s84, s100, 19
    s_add_u32 m0, s11, 122880
    s_add_u32 s84, s84, s13
    buffer_load_dwordx4 v20, s[48:51], s84 offen  lds
    s_add_u32 m0, m0, s87
    s_add_u32 s84, s84, s101
    buffer_load_dwordx4 v19, s[48:51], s84 offen  lds
    s_add_u32 m0, m0, s87
    s_add_u32 s84, s84, s101
    buffer_load_dwordx4 v20, s[48:51], s84 offen  lds
    s_add_u32 m0, m0, s87
    s_add_u32 s84, s84, s101
    buffer_load_dwordx4 v19, s[48:51], s84 offen  lds
    s_add_u32 m0, m0, s87
    s_add_u32 s84, s84, s101
    buffer_load_dwordx4 v20, s[48:51], s84 offen  lds
    s_add_u32 m0, m0, s87
    s_add_u32 s84, s84, s101
    buffer_load_dwordx4 v19, s[48:51], s84 offen  lds
    s_add_u32 m0, m0, s87
    s_add_u32 s84, s84, s101
    buffer_load_dwordx4 v20, s[48:51], s84 offen  lds
    s_add_u32 m0, m0, s87
    s_add_u32 s84, s84, s101
    buffer_load_dwordx4 v19, s[48:51], s84 offen  lds
    s_waitcnt vmcnt(20)
    s_barrier
    s_bfe_u32 s100, s98, 0x40014
    s_lshl_b32 s84, s100, 7
    s_add_u32 s84, s84, s14
    s_add_u32 m0, s9, 32768
    s_nop 0
    buffer_load_dwordx4 v21, s[44:47], s84 offen  lds
    s_add_u32 m0, s9, 36864
    s_add_u32 s84, s84, 65536
    buffer_load_dwordx4 v21, s[44:47], s84 offen  lds
    s_lshl_b32 s84, s100, 19
    s_add_u32 m0, s11, 0
    s_add_u32 s84, s84, s13
    buffer_load_dwordx4 v20, s[48:51], s84 offen  lds
    s_add_u32 m0, m0, s87
    s_add_u32 s84, s84, s101
    buffer_load_dwordx4 v19, s[48:51], s84 offen  lds
    s_add_u32 m0, m0, s87
    s_add_u32 s84, s84, s101
    buffer_load_dwordx4 v20, s[48:51], s84 offen  lds
    s_add_u32 m0, m0, s87
    s_add_u32 s84, s84, s101
    buffer_load_dwordx4 v19, s[48:51], s84 offen  lds
    s_add_u32 m0, m0, s87
    s_add_u32 s84, s84, s101
    buffer_load_dwordx4 v20, s[48:51], s84 offen  lds
    s_add_u32 m0, m0, s87
    s_add_u32 s84, s84, s101
    buffer_load_dwordx4 v19, s[48:51], s84 offen  lds
    s_add_u32 m0, m0, s87
    s_add_u32 s84, s84, s101
    buffer_load_dwordx4 v20, s[48:51], s84 offen  lds
    s_add_u32 m0, m0, s87
    s_add_u32 s84, s84, s101
    buffer_load_dwordx4 v19, s[48:51], s84 offen  lds
    s_waitcnt vmcnt(20)
    s_barrier
    s_bfe_u32 s100, s98, 0x40018
    s_lshl_b32 s84, s100, 7
    s_add_u32 s84, s84, s14
    s_add_u32 m0, s9, 73728
    s_nop 0
    buffer_load_dwordx4 v21, s[44:47], s84 offen  lds
    s_add_u32 m0, s9, 77824
    s_add_u32 s84, s84, 65536
    buffer_load_dwordx4 v21, s[44:47], s84 offen  lds
    s_lshl_b32 s84, s100, 19
    s_add_u32 m0, s11, 40960
    s_add_u32 s84, s84, s13
    buffer_load_dwordx4 v20, s[48:51], s84 offen  lds
    s_add_u32 m0, m0, s87
    s_add_u32 s84, s84, s101
    buffer_load_dwordx4 v19, s[48:51], s84 offen  lds
    s_add_u32 m0, m0, s87
    s_add_u32 s84, s84, s101
    buffer_load_dwordx4 v20, s[48:51], s84 offen  lds
    s_add_u32 m0, m0, s87
    s_add_u32 s84, s84, s101
    buffer_load_dwordx4 v19, s[48:51], s84 offen  lds
    s_add_u32 m0, m0, s87
    s_add_u32 s84, s84, s101
    buffer_load_dwordx4 v20, s[48:51], s84 offen  lds
    s_add_u32 m0, m0, s87
    s_add_u32 s84, s84, s101
    buffer_load_dwordx4 v19, s[48:51], s84 offen  lds
    s_add_u32 m0, m0, s87
    s_add_u32 s84, s84, s101
    buffer_load_dwordx4 v20, s[48:51], s84 offen  lds
    s_add_u32 m0, m0, s87
    s_add_u32 s84, s84, s101
    buffer_load_dwordx4 v19, s[48:51], s84 offen  lds
    s_waitcnt vmcnt(20)
    s_barrier
    s_bfe_u32 s100, s98, 0x4001c
    s_lshl_b32 s84, s100, 7
    s_add_u32 s84, s84, s14
    s_add_u32 m0, s9, 114688
    s_nop 0
    buffer_load_dwordx4 v21, s[44:47], s84 offen  lds
    s_add_u32 m0, s9, 118784
    s_add_u32 s84, s84, 65536
    buffer_load_dwordx4 v21, s[44:47], s84 offen  lds
    s_lshl_b32 s84, s100, 19
    s_add_u32 m0, s11, 81920
    s_add_u32 s84, s84, s13
    buffer_load_dwordx4 v20, s[48:51], s84 offen  lds
    s_add_u32 m0, m0, s87
    s_add_u32 s84, s84, s101
    buffer_load_dwordx4 v19, s[48:51], s84 offen  lds
    s_add_u32 m0, m0, s87
    s_add_u32 s84, s84, s101
    buffer_load_dwordx4 v20, s[48:51], s84 offen  lds
    s_add_u32 m0, m0, s87
    s_add_u32 s84, s84, s101
    buffer_load_dwordx4 v19, s[48:51], s84 offen  lds
    s_add_u32 m0, m0, s87
    s_add_u32 s84, s84, s101
    buffer_load_dwordx4 v20, s[48:51], s84 offen  lds
    s_add_u32 m0, m0, s87
    s_add_u32 s84, s84, s101
    buffer_load_dwordx4 v19, s[48:51], s84 offen  lds
    s_add_u32 m0, m0, s87
    s_add_u32 s84, s84, s101
    buffer_load_dwordx4 v20, s[48:51], s84 offen  lds
    s_add_u32 m0, m0, s87
    s_add_u32 s84, s84, s101
    buffer_load_dwordx4 v19, s[48:51], s84 offen  lds
    s_waitcnt vmcnt(20)
    s_barrier
    s_bfe_u32 s100, s99, 0x40000
    s_lshl_b32 s84, s100, 7
    s_add_u32 s84, s84, s14
    s_add_u32 m0, s9, 155648
    s_nop 0
    buffer_load_dwordx4 v21, s[44:47], s84 offen  lds
    s_add_u32 m0, s9, 159744
    s_add_u32 s84, s84, 65536
    buffer_load_dwordx4 v21, s[44:47], s84 offen  lds
    s_lshl_b32 s84, s100, 19
    s_add_u32 m0, s11, 122880
    s_add_u32 s84, s84, s13
    buffer_load_dwordx4 v20, s[48:51], s84 offen  lds
    s_add_u32 m0, m0, s87
    s_add_u32 s84, s84, s101
    buffer_load_dwordx4 v19, s[48:51], s84 offen  lds
    s_add_u32 m0, m0, s87
    s_add_u32 s84, s84, s101
    buffer_load_dwordx4 v20, s[48:51], s84 offen  lds
    s_add_u32 m0, m0, s87
    s_add_u32 s84, s84, s101
    buffer_load_dwordx4 v19, s[48:51], s84 offen  lds
    s_add_u32 m0, m0, s87
    s_add_u32 s84, s84, s101
    buffer_load_dwordx4 v20, s[48:51], s84 offen  lds
    s_add_u32 m0, m0, s87
    s_add_u32 s84, s84, s101
    buffer_load_dwordx4 v19, s[48:51], s84 offen  lds
    s_add_u32 m0, m0, s87
    s_add_u32 s84, s84, s101
    buffer_load_dwordx4 v20, s[48:51], s84 offen  lds
    s_add_u32 m0, m0, s87
    s_add_u32 s84, s84, s101
    buffer_load_dwordx4 v19, s[48:51], s84 offen  lds
    s_waitcnt vmcnt(20)
    s_barrier
    s_bfe_u32 s100, s99, 0x40004
    s_lshl_b32 s84, s100, 7
    s_add_u32 s84, s84, s14
    s_add_u32 m0, s9, 32768
    s_nop 0
    buffer_load_dwordx4 v21, s[44:47], s84 offen  lds
    s_add_u32 m0, s9, 36864
    s_add_u32 s84, s84, 65536
    buffer_load_dwordx4 v21, s[44:47], s84 offen  lds
    s_lshl_b32 s84, s100, 19
    s_add_u32 m0, s11, 0
    s_add_u32 s84, s84, s13
    buffer_load_dwordx4 v20, s[48:51], s84 offen  lds
    s_add_u32 m0, m0, s87
    s_add_u32 s84, s84, s101
    buffer_load_dwordx4 v19, s[48:51], s84 offen  lds
    s_add_u32 m0, m0, s87
    s_add_u32 s84, s84, s101
    buffer_load_dwordx4 v20, s[48:51], s84 offen  lds
    s_add_u32 m0, m0, s87
    s_add_u32 s84, s84, s101
    buffer_load_dwordx4 v19, s[48:51], s84 offen  lds
    s_add_u32 m0, m0, s87
    s_add_u32 s84, s84, s101
    buffer_load_dwordx4 v20, s[48:51], s84 offen  lds
    s_add_u32 m0, m0, s87
    s_add_u32 s84, s84, s101
    buffer_load_dwordx4 v19, s[48:51], s84 offen  lds
    s_add_u32 m0, m0, s87
    s_add_u32 s84, s84, s101
    buffer_load_dwordx4 v20, s[48:51], s84 offen  lds
    s_add_u32 m0, m0, s87
    s_add_u32 s84, s84, s101
    buffer_load_dwordx4 v19, s[48:51], s84 offen  lds
    s_waitcnt vmcnt(20)
    s_barrier
    s_bfe_u32 s100, s99, 0x40008
    s_lshl_b32 s84, s100, 7
    s_add_u32 s84, s84, s14
    s_add_u32 m0, s9, 73728
    s_nop 0
    buffer_load_dwordx4 v21, s[44:47], s84 offen  lds
    s_add_u32 m0, s9, 77824
    s_add_u32 s84, s84, 65536
    buffer_load_dwordx4 v21, s[44:47], s84 offen  lds
    s_lshl_b32 s84, s100, 19
    s_add_u32 m0, s11, 40960
    s_add_u32 s84, s84, s13
    buffer_load_dwordx4 v20, s[48:51], s84 offen  lds
    s_add_u32 m0, m0, s87
    s_add_u32 s84, s84, s101
    buffer_load_dwordx4 v19, s[48:51], s84 offen  lds
    s_add_u32 m0, m0, s87
    s_add_u32 s84, s84, s101
    buffer_load_dwordx4 v20, s[48:51], s84 offen  lds
    s_add_u32 m0, m0, s87
    s_add_u32 s84, s84, s101
    buffer_load_dwordx4 v19, s[48:51], s84 offen  lds
    s_add_u32 m0, m0, s87
    s_add_u32 s84, s84, s101
    buffer_load_dwordx4 v20, s[48:51], s84 offen  lds
    s_add_u32 m0, m0, s87
    s_add_u32 s84, s84, s101
    buffer_load_dwordx4 v19, s[48:51], s84 offen  lds
    s_add_u32 m0, m0, s87
    s_add_u32 s84, s84, s101
    buffer_load_dwordx4 v20, s[48:51], s84 offen  lds
    s_add_u32 m0, m0, s87
    s_add_u32 s84, s84, s101
    buffer_load_dwordx4 v19, s[48:51], s84 offen  lds
    s_waitcnt vmcnt(20)
    s_barrier
    s_bfe_u32 s100, s99, 0x4000c
    s_lshl_b32 s84, s100, 7
    s_add_u32 s84, s84, s14
    s_add_u32 m0, s9, 114688
    s_nop 0
    buffer_load_dwordx4 v21, s[44:47], s84 offen  lds
    s_add_u32 m0, s9, 118784
    s_add_u32 s84, s84, 65536
    buffer_load_dwordx4 v21, s[44:47], s84 offen  lds
    s_lshl_b32 s84, s100, 19
    s_add_u32 m0, s11, 81920
    s_add_u32 s84, s84, s13
    buffer_load_dwordx4 v20, s[48:51], s84 offen  lds
    s_add_u32 m0, m0, s87
    s_add_u32 s84, s84, s101
    buffer_load_dwordx4 v19, s[48:51], s84 offen  lds
    s_add_u32 m0, m0, s87
    s_add_u32 s84, s84, s101
    buffer_load_dwordx4 v20, s[48:51], s84 offen  lds
    s_add_u32 m0, m0, s87
    s_add_u32 s84, s84, s101
    buffer_load_dwordx4 v19, s[48:51], s84 offen  lds
    s_add_u32 m0, m0, s87
    s_add_u32 s84, s84, s101
    buffer_load_dwordx4 v20, s[48:51], s84 offen  lds
    s_add_u32 m0, m0, s87
    s_add_u32 s84, s84, s101
    buffer_load_dwordx4 v19, s[48:51], s84 offen  lds
    s_add_u32 m0, m0, s87
    s_add_u32 s84, s84, s101
    buffer_load_dwordx4 v20, s[48:51], s84 offen  lds
    s_add_u32 m0, m0, s87
    s_add_u32 s84, s84, s101
    buffer_load_dwordx4 v19, s[48:51], s84 offen  lds
    s_cmp_lg_u32 s42, 0
    s_cbranch_scc1 L_kt11
    s_cmp_ge_u32 s8, 2
    s_cbranch_scc1 L_ktv11
    buffer_load_dword v26, v24, s[52:55], s16 offen
    s_branch L_kt11
L_ktv11:
    buffer_load_dword v26, v24, s[56:59], s16 offen
L_kt11:
    s_waitcnt vmcnt(20)
    s_barrier
    s_bfe_u32 s100, s99, 0x40010
    s_lshl_b32 s84, s100, 7
    s_add_u32 s84, s84, s14
    s_add_u32 m0, s9, 155648
    s_nop 0
    buffer_load_dwordx4 v21, s[44:47], s84 offen  lds
    s_add_u32 m0, s9, 159744
    s_add_u32 s84, s84, 65536
    buffer_load_dwordx4 v21, s[44:47], s84 offen  lds
    s_lshl_b32 s84, s100, 19
    s_add_u32 m0, s11, 122880
    s_add_u32 s84, s84, s13
    buffer_load_dwordx4 v20, s[48:51], s84 offen  lds
    s_add_u32 m0, m0, s87
    s_add_u32 s84, s84, s101
    buffer_load_dwordx4 v19, s[48:51], s84 offen  lds
    s_add_u32 m0, m0, s87
    s_add_u32 s84, s84, s101
    buffer_load_dwordx4 v20, s[48:51], s84 offen  lds
    s_add_u32 m0, m0, s87
    s_add_u32 s84, s84, s101
    buffer_load_dwordx4 v19, s[48:51], s84 offen  lds
    s_add_u32 m0, m0, s87
    s_add_u32 s84, s84, s101
    buffer_load_dwordx4 v20, s[48:51], s84 offen  lds
    s_add_u32 m0, m0, s87
    s_add_u32 s84, s84, s101
    buffer_load_dwordx4 v19, s[48:51], s84 offen  lds
    s_add_u32 m0, m0, s87
    s_add_u32 s84, s84, s101
    buffer_load_dwordx4 v20, s[48:51], s84 offen  lds
    s_add_u32 m0, m0, s87
    s_add_u32 s84, s84, s101
    buffer_load_dwordx4 v19, s[48:51], s84 offen  lds
    s_cmp_lg_u32 s42, 1
    s_cbranch_scc1 L_kt12
    s_cmp_ge_u32 s8, 2
    s_cbranch_scc1 L_ktv12
    buffer_load_dword v26, v24, s[52:55], s16 offen
    s_branch L_kt12
L_ktv12:
    buffer_load_dword v26, v24, s[56:59], s16 offen
L_kt12:
    s_waitcnt vmcnt(20)
    s_barrier
    s_bfe_u32 s100, s99, 0x40014
    s_lshl_b32 s84, s100, 7
    s_add_u32 s84, s84, s14
    s_add_u32 m0, s9, 32768
    s_nop 0
    buffer_load_dwordx4 v21, s[44:47], s84 offen  lds
    s_add_u32 m0, s9, 36864
    s_add_u32 s84, s84, 65536
    buffer_load_dwordx4 v21, s[44:47], s84 offen  lds
    s_lshl_b32 s84, s100, 19
    s_add_u32 m0, s11, 0
    s_add_u32 s84, s84, s13
    buffer_load_dwordx4 v20, s[48:51], s84 offen  lds
    s_add_u32 m0, m0, s87
    s_add_u32 s84, s84, s101
    buffer_load_dwordx4 v19, s[48:51], s84 offen  lds
    s_add_u32 m0, m0, s87
    s_add_u32 s84, s84, s101
    buffer_load_dwordx4 v20, s[48:51], s84 offen  lds
    s_add_u32 m0, m0, s87
    s_add_u32 s84, s84, s101
    buffer_load_dwordx4 v19, s[48:51], s84 offen  lds
    s_add_u32 m0, m0, s87
    s_add_u32 s84, s84, s101
    buffer_load_dwordx4 v20, s[48:51], s84 offen  lds
    s_add_u32 m0, m0, s87
    s_add_u32 s84, s84, s101
    buffer_load_dwordx4 v19, s[48:51], s84 offen  lds
    s_add_u32 m0, m0, s87
    s_add_u32 s84, s84, s101
    buffer_load_dwordx4 v20, s[48:51], s84 offen  lds
    s_add_u32 m0, m0, s87
    s_add_u32 s84, s84, s101
    buffer_load_dwordx4 v19, s[48:51], s84 offen  lds
    s_cmp_lg_u32 s42, 2
    s_cbranch_scc1 L_kt13
    s_cmp_ge_u32 s8, 2
    s_cbranch_scc1 L_ktv13
    buffer_load_dword v26, v24, s[52:55], s16 offen
    s_branch L_kt13
L_ktv13:
    buffer_load_dword v26, v24, s[56:59], s16 offen
L_kt13:
    s_waitcnt vmcnt(20)
    s_barrier
    s_bfe_u32 s100, s99, 0x40018
    s_lshl_b32 s84, s100, 7
L_pr0:
    s_cbranch_execz L_pr4
    s_add_u32 s84, s84, s14
    s_add_u32 m0, s9, 73728
    s_nop 0
    buffer_load_dwordx4 v21, s[44:47], s84 offen  lds
    s_add_u32 m0, s9, 77824
    s_add_u32 s84, s84, 65536
    buffer_load_dwordx4 v21, s[44:47], s84 offen  lds
    s_lshl_b32 s84, s100, 19
    s_add_u32 m0, s11, 40960
    s_add_u32 s84, s84, s13
    buffer_load_dwordx4 v20, s[48:51], s84 offen  lds
    s_add_u32 m0, m0, s87
    s_add_u32 s84, s84, s101
    buffer_load_dwordx4 v19, s[48:51], s84 offen  lds
    s_add_u32 m0, m0, s87
    s_add_u32 s84, s84, s101
    buffer_load_dwordx4 v20, s[48:51], s84 offen  lds
    s_add_u32 m0, m0, s87
    s_add_u32 s84, s84, s101
    buffer_load_dwordx4 v19, s[48:51], s84 offen  lds
    s_add_u32 m0, m0, s87
    s_add_u32 s84, s84, s101
    buffer_load_dwordx4 v20, s[48:51], s84 offen  lds
    s_add_u32 m0, m0, s87
    s_add_u32 s84, s84, s101
    buffer_load_dwordx4 v19, s[48:51], s84 offen  lds
    s_add_u32 m0, m0, s87
    s_add_u32 s84, s84, s101
    buffer_load_dwordx4 v20, s[48:51], s84 offen  lds
    s_add_u32 m0, m0, s87
    s_add_u32 s84, s84, s101
    buffer_load_dwordx4 v19, s[48:51], s84 offen  lds
    s_cmp_lg_u32 s42, 3
    s_cbranch_scc1 L_kt14
    s_cmp_ge_u32 s8, 2
    s_cbranch_scc1 L_ktv14
    buffer_load_dword v26, v24, s[52:55], s16 offen
    s_branch L_kt14
L_ktv14:
    buffer_load_dword v26, v24, s[56:59], s16 offen
L_kt14:
    s_waitcnt vmcnt(20)
    s_barrier
    s_bfe_u32 s100, s99, 0x4001c
    s_lshl_b32 s84, s100, 7
    s_add_u32 s84, s84, s14
    s_add_u32 m0, s9, 114688
    s_nop 0
    buffer_load_dwordx4 v21, s[44:47], s84 offen  lds
    s_add_u32 m0, s9, 118784
    s_add_u32 s84, s84, 65536
    buffer_load_dwordx4 v21, s[44:47], s84 offen  lds
    s_lshl_b32 s84, s100, 19
    s_add_u32 m0, s11, 81920
    s_add_u32 s84, s84, s13
    buffer_load_dwordx4 v20, s[48:51], s84 offen  lds
    s_add_u32 m0, m0, s87
    s_add_u32 s84, s84, s101
    buffer_load_dwordx4 v19, s[48:51], s84 offen  lds
    s_add_u32 m0, m0, s87
    s_add_u32 s84, s84, s101
    buffer_load_dwordx4 v20, s[48:51], s84 offen  lds
    s_add_u32 m0, m0, s87
    s_add_u32 s84, s84, s101
    buffer_load_dwordx4 v19, s[48:51], s84 offen  lds
    s_add_u32 m0, m0, s87
    s_add_u32 s84, s84, s101
    buffer_load_dwordx4 v20, s[48:51], s84 offen  lds
    s_add_u32 m0, m0, s87
    s_add_u32 s84, s84, s101
    buffer_load_dwordx4 v19, s[48:51], s84 offen  lds
    s_add_u32 m0, m0, s87
    s_add_u32 s84, s84, s101
    buffer_load_dwordx4 v20, s[48:51], s84 offen  lds
    s_add_u32 m0, m0, s87
    s_add_u32 s84, s84, s101
    buffer_load_dwordx4 v19, s[48:51], s84 offen  lds
    s_waitcnt vmcnt(20)
    s_barrier
    s_bfe_u32 s100, s82, 0x40000
    s_lshl_b32 s84, s100, 13
    s_add_u32 s84, s84, s15
    s_add_u32 m0, s12, 122880
    s_nop 0
    buffer_load_dwordx4 v22, s[52:55], s84 offen  lds
    s_add_u32 m0, s12, 123968
    s_add_u32 s84, s84, 1024
    buffer_load_dwordx4 v22, s[52:55], s84 offen  lds
    s_add_u32 m0, s12, 131584
    s_add_u32 s84, s84, 523264
    buffer_load_dwordx4 v22, s[52:55], s84 offen  lds
    s_add_u32 m0, s12, 132672
    s_add_u32 s84, s84, 1024
    buffer_load_dwordx4 v22, s[52:55], s84 offen  lds
    s_waitcnt vmcnt(14)
    s_barrier
    s_bfe_u32 s100, s82, 0x40000
    s_lshl_b32 s84, s100, 13
    s_add_u32 s84, s84, s15
    s_add_u32 m0, s12, 17408
    s_nop 0
    buffer_load_dwordx4 v23, s[56:59], s84 offen  lds
    s_add_u32 m0, s12, 18496
    s_add_u32 s84, s84, 1024
    buffer_load_dwordx4 v23, s[56:59], s84 offen  lds
    s_add_u32 m0, s12, 26112
    s_add_u32 s84, s84, 523264
    buffer_load_dwordx4 v23, s[56:59], s84 offen  lds
    s_add_u32 m0, s12, 27200
    s_add_u32 s84, s84, 1024
    buffer_load_dwordx4 v23, s[56:59], s84 offen  lds
    s_bfe_u32 s100, s82, 0x40004
    s_lshl_b32 s84, s100, 13
    s_add_u32 s84, s84, s15
    s_add_u32 m0, s12, 0
    s_nop 0
    buffer_load_dwordx4 v22, s[52:55], s84 offen  lds
    s_add_u32 m0, s12, 1088
    s_add_u32 s84, s84, 1024
    buffer_load_dwordx4 v22, s[52:55], s84 offen  lds
    s_add_u32 m0, s12, 8704
    s_add_u32 s84, s84, 523264
    buffer_load_dwordx4 v22, s[52:55], s84 offen  lds
    s_add_u32 m0, s12, 9792
    s_add_u32 s84, s84, 1024
    buffer_load_dwordx4 v22, s[52:55], s84 offen  lds
    s_waitcnt vmcnt(12)
    s_barrier
    s_bfe_u32 s100, s82, 0x40004
    s_lshl_b32 s84, s100, 13
    s_add_u32 s84, s84, s15
    s_add_u32 m0, s12, 58368
    s_nop 0
    buffer_load_dwordx4 v23, s[56:59], s84 offen  lds
    s_add_u32 m0, s12, 59456
    s_add_u32 s84, s84, 1024
    buffer_load_dwordx4 v23, s[56:59], s84 offen  lds
    s_add_u32 m0, s12, 67072
    s_add_u32 s84, s84, 523264
    buffer_load_dwordx4 v23, s[56:59], s84 offen  lds
    s_add_u32 m0, s12, 68160
    s_add_u32 s84, s84, 1024
    buffer_load_dwordx4 v23, s[56:59], s84 offen  lds
    s_bfe_u32 s100, s82, 0x40008
    s_lshl_b32 s84, s100, 13
    s_add_u32 s84, s84, s15
    s_add_u32 m0, s12, 40960
    s_nop 0
    buffer_load_dwordx4 v22, s[52:55], s84 offen  lds
    s_add_u32 m0, s12, 42048
    s_add_u32 s84, s84, 1024
    buffer_load_dwordx4 v22, s[52:55], s84 offen  lds
    s_add_u32 m0, s12, 49664
    s_add_u32 s84, s84, 523264
    buffer_load_dwordx4 v22, s[52:55], s84 offen  lds
    s_add_u32 m0, s12, 50752
    s_add_u32 s84, s84, 1024
    buffer_load_dwordx4 v22, s[52:55], s84 offen  lds
    s_waitcnt vmcnt(16)
    s_barrier
    s_bfe_u32 s100, s82, 0x40008
    s_lshl_b32 s84, s100, 13
    s_add_u32 s84, s84, s15
    s_add_u32 m0, s12, 99328
    s_nop 0
    buffer_load_dwordx4 v23, s[56:59], s84 offen  lds
    s_add_u32 m0, s12, 100416
    s_add_u32 s84, s84, 1024
    buffer_load_dwordx4 v23, s[56:59], s84 offen  lds
    s_add_u32 m0, s12, 108032
    s_add_u32 s84, s84, 523264
    buffer_load_dwordx4 v23, s[56:59], s84 offen  lds
    s_add_u32 m0, s12, 109120
    s_add_u32 s84, s84, 1024
    buffer_load_dwordx4 v23, s[56:59], s84 offen  lds
    s_bfe_u32 s100, s82, 0x4000c
    s_lshl_b32 s84, s100, 13
    s_add_u32 s84, s84, s15
    s_add_u32 m0, s12, 81920
    s_nop 0
    buffer_load_dwordx4 v22, s[52:55], s84 offen  lds
    s_add_u32 m0, s12, 83008
    s_add_u32 s84, s84, 1024
    buffer_load_dwordx4 v22, s[52:55], s84 offen  lds
    s_add_u32 m0, s12, 90624
    s_add_u32 s84, s84, 523264
    buffer_load_dwordx4 v22, s[52:55], s84 offen  lds
    s_add_u32 m0, s12, 91712
    s_add_u32 s84, s84, 1024
    buffer_load_dwordx4 v22, s[52:55], s84 offen  lds
    s_waitcnt vmcnt(16)
    s_barrier
    s_bfe_u32 s100, s82, 0x4000c
    s_lshl_b32 s84, s100, 13
    s_add_u32 s84, s84, s15
    s_add_u32 m0, s12, 140288
    s_nop 0
    buffer_load_dwordx4 v23, s[56:59], s84 offen  lds
    s_add_u32 m0, s12, 141376
    s_add_u32 s84, s84, 1024
    buffer_load_dwordx4 v23, s[56:59], s84 offen  lds
    s_add_u32 m0, s12, 148992
    s_add_u32 s84, s84, 523264
    buffer_load_dwordx4 v23, s[56:59], s84 offen  lds
    s_add_u32 m0, s12, 150080
    s_add_u32 s84, s84, 1024
    buffer_load_dwordx4 v23, s[56:59], s84 offen  lds
    s_bfe_u32 s100, s82, 0x40010
    s_lshl_b32 s84, s100, 13
    s_add_u32 s84, s84, s15
    s_add_u32 m0, s12, 122880
    s_nop 0
    buffer_load_dwordx4 v22, s[52:55], s84 offen  lds
    s_add_u32 m0, s12, 123968
    s_add_u32 s84, s84, 1024
    buffer_load_dwordx4 v22, s[52:55], s84 offen  lds
    s_add_u32 m0, s12, 131584
    s_add_u32 s84, s84, 523264
    buffer_load_dwordx4 v22, s[52:55], s84 offen  lds
    s_add_u32 m0, s12, 132672
    s_add_u32 s84, s84, 1024
    buffer_load_dwordx4 v22, s[52:55], s84 offen  lds
    s_waitcnt vmcnt(16)
    s_barrier
    s_bfe_u32 s100, s82, 0x40010
    s_lshl_b32 s84, s100, 13
    s_add_u32 s84, s84, s15
    s_add_u32 m0, s12, 17408
    s_nop 0
    buffer_load_dwordx4 v23, s[56:59], s84 offen  lds
    s_add_u32 m0, s12, 18496
    s_add_u32 s84, s84, 1024
    buffer_load_dwordx4 v23, s[56:59], s84 offen  lds
    s_add_u32 m0, s12, 26112
    s_add_u32 s84, s84, 523264
    buffer_load_dwordx4 v23, s[56:59], s84 offen  lds
    s_add_u32 m0, s12, 27200
    s_add_u32 s84, s84, 1024
    buffer_load_dwordx4 v23, s[56:59], s84 offen  lds
    s_bfe_u32 s100, s82, 0x40014
    s_lshl_b32 s84, s100, 13
    s_add_u32 s84, s84, s15
    s_add_u32 m0, s12, 0
    s_nop 0
    buffer_load_dwordx4 v22, s[52:55], s84 offen  lds
    s_add_u32 m0, s12, 1088
    s_add_u32 s84, s84, 1024
    buffer_load_dwordx4 v22, s[52:55], s84 offen  lds
    s_add_u32 m0, s12, 8704
    s_add_u32 s84, s84, 523264
    buffer_load_dwordx4 v22, s[52:55], s84 offen  lds
    s_add_u32 m0, s12, 9792
    s_add_u32 s84, s84, 1024
    buffer_load_dwordx4 v22, s[52:55], s84 offen  lds
    s_waitcnt vmcnt(16)
    s_barrier
    s_bfe_u32 s100, s82, 0x40014
    s_lshl_b32 s84, s100, 13
    s_add_u32 s84, s84, s15
    s_add_u32 m0, s12, 58368
    s_nop 0
    buffer_load_dwordx4 v23, s[56:59], s84 offen  lds
    s_add_u32 m0, s12, 59456
    s_add_u32 s84, s84, 1024
    buffer_load_dwordx4 v23, s[56:59], s84 offen  lds
    s_add_u32 m0, s12, 67072
    s_add_u32 s84, s84, 523264
    buffer_load_dwordx4 v23, s[56:59], s84 offen  lds
    s_add_u32 m0, s12, 68160
    s_add_u32 s84, s84, 1024
    buffer_load_dwordx4 v23, s[56:59], s84 offen  lds
    s_bfe_u32 s100, s82, 0x40018
    s_lshl_b32 s84, s100, 13
    s_add_u32 s84, s84, s15
    s_add_u32 m0, s12, 40960
    s_nop 0
    buffer_load_dwordx4 v22, s[52:55], s84 offen  lds
    s_add_u32 m0, s12, 42048
    s_add_u32 s84, s84, 1024
    buffer_load_dwordx4 v22, s[52:55], s84 offen  lds
    s_add_u32 m0, s12, 49664
    s_add_u32 s84, s84, 523264
    buffer_load_dwordx4 v22, s[52:55], s84 offen  lds
    s_add_u32 m0, s12, 50752
    s_add_u32 s84, s84, 1024
    buffer_load_dwordx4 v22, s[52:55], s84 offen  lds
    s_waitcnt vmcnt(16)
    s_barrier
    s_bfe_u32 s100, s82, 0x40018
    s_lshl_b32 s84, s100, 13
    s_add_u32 s84, s84, s15
    s_add_u32 m0, s12, 99328
    s_nop 0
    buffer_load_dwordx4 v23, s[56:59], s84 offen  lds
    s_add_u32 m0, s12, 100416
    s_add_u32 s84, s84, 1024
    buffer_load_dwordx4 v23, s[56:59], s84 offen  lds
    s_add_u32 m0, s12, 108032
    s_add_u32 s84, s84, 523264
    buffer_load_dwordx4 v23, s[56:59], s84 offen  lds
    s_add_u32 m0, s12, 109120
    s_add_u32 s84, s84, 1024
    buffer_load_dwordx4 v23, s[56:59], s84 offen  lds
    s_bfe_u32 s100, s82, 0x4001c
    s_lshl_b32 s84, s100, 13
    s_add_u32 s84, s84, s15
    s_add_u32 m0, s12, 81920
    s_nop 0
    buffer_load_dwordx4 v22, s[52:55], s84 offen  lds
    s_add_u32 m0, s12, 83008
    s_add_u32 s84, s84, 1024
    buffer_load_dwordx4 v22, s[52:55], s84 offen  lds
    s_add_u32 m0, s12, 90624
    s_add_u32 s84, s84, 523264
    buffer_load_dwordx4 v22, s[52:55], s84 offen  lds
    s_add_u32 m0, s12, 91712
    s_add_u32 s84, s84, 1024
    buffer_load_dwordx4 v22, s[52:55], s84 offen  lds
    s_waitcnt vmcnt(16)
    s_barrier
    s_bfe_u32 s100, s82, 0x4001c
    s_lshl_b32 s84, s100, 13
    s_add_u32 s84, s84, s15
    s_add_u32 m0, s12, 140288
    s_nop 0
    buffer_load_dwordx4 v23, s[56:59], s84 offen  lds
    s_add_u32 m0, s12, 141376
    s_add_u32 s84, s84, 1024
    buffer_load_dwordx4 v23, s[56:59], s84 offen  lds
    s_add_u32 m0, s12, 148992
    s_add_u32 s84, s84, 523264
    buffer_load_dwordx4 v23, s[56:59], s84 offen  lds
    s_add_u32 m0, s12, 150080
    s_add_u32 s84, s84, 1024
    buffer_load_dwordx4 v23, s[56:59], s84 offen  lds
    s_bfe_u32 s100, s83, 0x40000
    s_lshl_b32 s84, s100, 13
    s_add_u32 s84, s84, s15
    s_add_u32 m0, s12, 122880
    s_nop 0
    buffer_load_dwordx4 v22, s[52:55], s84 offen  lds
    s_add_u32 m0, s12, 123968
    s_add_u32 s84, s84, 1024
    buffer_load_dwordx4 v22, s[52:55], s84 offen  lds
    s_add_u32 m0, s12, 131584
    s_add_u32 s84, s84, 523264
    buffer_load_dwordx4 v22, s[52:55], s84 offen  lds
    s_add_u32 m0, s12, 132672
    s_add_u32 s84, s84, 1024
    buffer_load_dwordx4 v22, s[52:55], s84 offen  lds
    s_waitcnt vmcnt(16)
    s_barrier
    s_bfe_u32 s100, s83, 0x40000
    s_lshl_b32 s84, s100, 13
    s_add_u32 s84, s84, s15
    s_add_u32 m0, s12, 17408
    s_nop 0
    buffer_load_dwordx4 v23, s[56:59], s84 offen  lds
    s_add_u32 m0, s12, 18496
    s_add_u32 s84, s84, 1024
    buffer_load_dwordx4 v23, s[56:59], s84 offen  lds
    s_add_u32 m0, s12, 26112
    s_add_u32 s84, s84, 523264
    buffer_load_dwordx4 v23, s[56:59], s84 offen  lds
    s_add_u32 m0, s12, 27200
    s_add_u32 s84, s84, 1024
    buffer_load_dwordx4 v23, s[56:59], s84 offen  lds
    s_bfe_u32 s100, s83, 0x40004
    s_lshl_b32 s84, s100, 13
    s_add_u32 s84, s84, s15
    s_add_u32 m0, s12, 0
    s_nop 0
    buffer_load_dwordx4 v22, s[52:55], s84 offen  lds
    s_add_u32 m0, s12, 1088
    s_add_u32 s84, s84, 1024
    buffer_load_dwordx4 v22, s[52:55], s84 offen  lds
    s_add_u32 m0, s12, 8704
    s_add_u32 s84, s84, 523264
    buffer_load_dwordx4 v22, s[52:55], s84 offen  lds
    s_add_u32 m0, s12, 9792
    s_add_u32 s84, s84, 1024
    buffer_load_dwordx4 v22, s[52:55], s84 offen  lds
    s_waitcnt vmcnt(16)
    s_barrier
    s_bfe_u32 s100, s83, 0x40004
    s_lshl_b32 s84, s100, 13
    s_add_u32 s84, s84, s15
    s_add_u32 m0, s12, 58368
    s_nop 0
    buffer_load_dwordx4 v23, s[56:59], s84 offen  lds
    s_add_u32 m0, s12, 59456
    s_add_u32 s84, s84, 1024
    buffer_load_dwordx4 v23, s[56:59], s84 offen  lds
    s_add_u32 m0, s12, 67072
    s_add_u32 s84, s84, 523264
    buffer_load_dwordx4 v23, s[56:59], s84 offen  lds
    s_add_u32 m0, s12, 68160
    s_add_u32 s84, s84, 1024
    buffer_load_dwordx4 v23, s[56:59], s84 offen  lds
    s_bfe_u32 s100, s83, 0x40008
    s_lshl_b32 s84, s100, 13
    s_add_u32 s84, s84, s15
    s_add_u32 m0, s12, 40960
    s_nop 0
    buffer_load_dwordx4 v22, s[52:55], s84 offen  lds
    s_add_u32 m0, s12, 42048
    s_add_u32 s84, s84, 1024
    buffer_load_dwordx4 v22, s[52:55], s84 offen  lds
    s_add_u32 m0, s12, 49664
    s_add_u32 s84, s84, 523264
    buffer_load_dwordx4 v22, s[52:55], s84 offen  lds
    s_add_u32 m0, s12, 50752
    s_add_u32 s84, s84, 1024
    buffer_load_dwordx4 v22, s[52:55], s84 offen  lds
    s_waitcnt vmcnt(16)
    s_barrier
    s_bfe_u32 s100, s83, 0x40008
    s_lshl_b32 s84, s100, 13
    s_add_u32 s84, s84, s15
    s_add_u32 m0, s12, 99328
    s_nop 0
    buffer_load_dwordx4 v23, s[56:59], s84 offen  lds
    s_add_u32 m0, s12, 100416
    s_add_u32 s84, s84, 1024
    buffer_load_dwordx4 v23, s[56:59], s84 offen  lds
    s_add_u32 m0, s12, 108032
    s_add_u32 s84, s84, 523264
    buffer_load_dwordx4 v23, s[56:59], s84 offen  lds
    s_add_u32 m0, s12, 109120
    s_add_u32 s84, s84, 1024
    buffer_load_dwordx4 v23, s[56:59], s84 offen  lds
    s_bfe_u32 s100, s83, 0x4000c
    s_lshl_b32 s84, s100, 13
    s_add_u32 s84, s84, s15
    s_add_u32 m0, s12, 81920
    s_nop 0
    buffer_load_dwordx4 v22, s[52:55], s84 offen  lds
    s_add_u32 m0, s12, 83008
    s_add_u32 s84, s84, 1024
    buffer_load_dwordx4 v22, s[52:55], s84 offen  lds
    s_add_u32 m0, s12, 90624
    s_add_u32 s84, s84, 523264
    buffer_load_dwordx4 v22, s[52:55], s84 offen  lds
    s_add_u32 m0, s12, 91712
    s_add_u32 s84, s84, 1024
    buffer_load_dwordx4 v22, s[52:55], s84 offen  lds
    s_waitcnt vmcnt(16)
    s_barrier
    s_bfe_u32 s100, s83, 0x4000c
    s_lshl_b32 s84, s100, 13
    s_add_u32 s84, s84, s15
    s_add_u32 m0, s12, 140288
    s_nop 0
    buffer_load_dwordx4 v23, s[56:59], s84 offen  lds
    s_add_u32 m0, s12, 141376
    s_add_u32 s84, s84, 1024
    buffer_load_dwordx4 v23, s[56:59], s84 offen  lds
    s_add_u32 m0, s12, 148992
    s_add_u32 s84, s84, 523264
    buffer_load_dwordx4 v23, s[56:59], s84 offen  lds
    s_add_u32 m0, s12, 150080
    s_add_u32 s84, s84, 1024
    buffer_load_dwordx4 v23, s[56:59], s84 offen  lds
    s_bfe_u32 s100, s83, 0x40010
    s_lshl_b32 s84, s100, 13
    s_add_u32 s84, s84, s15
    s_add_u32 m0, s12, 122880
    s_nop 0
    buffer_load_dwordx4 v22, s[52:55], s84 offen  lds
    s_add_u32 m0, s12, 123968
    s_add_u32 s84, s84, 1024
    buffer_load_dwordx4 v22, s[52:55], s84 offen  lds
    s_add_u32 m0, s12, 131584
    s_add_u32 s84, s84, 523264
    buffer_load_dwordx4 v22, s[52:55], s84 offen  lds
    s_add_u32 m0, s12, 132672
    s_add_u32 s84, s84, 1024
    buffer_load_dwordx4 v22, s[52:55], s84 offen  lds
    s_waitcnt vmcnt(16)
    s_barrier
    s_bfe_u32 s100, s83, 0x40010
    s_lshl_b32 s84, s100, 13
    s_add_u32 s84, s84, s15
    s_add_u32 m0, s12, 17408
    s_nop 0
    buffer_load_dwordx4 v23, s[56:59], s84 offen  lds
    s_add_u32 m0, s12, 18496
    s_add_u32 s84, s84, 1024
    buffer_load_dwordx4 v23, s[56:59], s84 offen  lds
    s_add_u32 m0, s12, 26112
    s_add_u32 s84, s84, 523264
    buffer_load_dwordx4 v23, s[56:59], s84 offen  lds
    s_add_u32 m0, s12, 27200
    s_add_u32 s84, s84, 1024
    buffer_load_dwordx4 v23, s[56:59], s84 offen  lds
    s_bfe_u32 s100, s83, 0x40014
    s_lshl_b32 s84, s100, 13
    s_add_u32 s84, s84, s15
    s_add_u32 m0, s12, 0
    s_nop 0
    buffer_load_dwordx4 v22, s[52:55], s84 offen  lds
    s_add_u32 m0, s12, 1088
    s_add_u32 s84, s84, 1024
    buffer_load_dwordx4 v22, s[52:55], s84 offen  lds
    s_add_u32 m0, s12, 8704
    s_add_u32 s84, s84, 523264
    buffer_load_dwordx4 v22, s[52:55], s84 offen  lds
    s_add_u32 m0, s12, 9792
    s_add_u32 s84, s84, 1024
    buffer_load_dwordx4 v22, s[52:55], s84 offen  lds
    s_waitcnt vmcnt(16)
    s_barrier
    s_bfe_u32 s100, s83, 0x40014
    s_lshl_b32 s84, s100, 13
    s_add_u32 s84, s84, s15
    s_add_u32 m0, s12, 58368
    s_nop 0
    buffer_load_dwordx4 v23, s[56:59], s84 offen  lds
    s_add_u32 m0, s12, 59456
    s_add_u32 s84, s84, 1024
    buffer_load_dwordx4 v23, s[56:59], s84 offen  lds
    s_add_u32 m0, s12, 67072
    s_add_u32 s84, s84, 523264
    buffer_load_dwordx4 v23, s[56:59], s84 offen  lds
    s_add_u32 m0, s12, 68160
    s_add_u32 s84, s84, 1024
    buffer_load_dwordx4 v23, s[56:59], s84 offen  lds
    s_bfe_u32 s100, s83, 0x40018
    s_lshl_b32 s84, s100, 13
    s_add_u32 s84, s84, s15
    s_add_u32 m0, s12, 40960
    s_nop 0
    buffer_load_dwordx4 v22, s[52:55], s84 offen  lds
    s_add_u32 m0, s12, 42048
    s_add_u32 s84, s84, 1024
    buffer_load_dwordx4 v22, s[52:55], s84 offen  lds
    s_add_u32 m0, s12, 49664
    s_add_u32 s84, s84, 523264
    buffer_load_dwordx4 v22, s[52:55], s84 offen  lds
    s_add_u32 m0, s12, 50752
    s_add_u32 s84, s84, 1024
    buffer_load_dwordx4 v22, s[52:55], s84 offen  lds
    s_waitcnt vmcnt(16)
    s_barrier
    s_bfe_u32 s100, s83, 0x40018
    s_lshl_b32 s84, s100, 13
    s_add_u32 s84, s84, s15
    s_add_u32 m0, s12, 99328
    s_nop 0
    buffer_load_dwordx4 v23, s[56:59], s84 offen  lds
    s_add_u32 m0, s12, 100416
    s_add_u32 s84, s84, 1024
    buffer_load_dwordx4 v23, s[56:59], s84 offen  lds
    s_add_u32 m0, s12, 108032
    s_add_u32 s84, s84, 523264
    buffer_load_dwordx4 v23, s[56:59], s84 offen  lds
    s_add_u32 m0, s12, 109120
    s_add_u32 s84, s84, 1024
    buffer_load_dwordx4 v23, s[56:59], s84 offen  lds
    s_bfe_u32 s100, s83, 0x4001c
    s_lshl_b32 s84, s100, 13
    s_add_u32 s84, s84, s15
    s_add_u32 m0, s12, 81920
    s_nop 0
    buffer_load_dwordx4 v22, s[52:55], s84 offen  lds
    s_add_u32 m0, s12, 83008
    s_add_u32 s84, s84, 1024
    buffer_load_dwordx4 v22, s[52:55], s84 offen  lds
    s_add_u32 m0, s12, 90624
    s_add_u32 s84, s84, 523264
    buffer_load_dwordx4 v22, s[52:55], s84 offen  lds
    s_add_u32 m0, s12, 91712
    s_add_u32 s84, s84, 1024
    buffer_load_dwordx4 v22, s[52:55], s84 offen  lds
    s_waitcnt vmcnt(16)
    s_barrier
    s_bfe_u32 s100, s83, 0x4001c
    s_lshl_b32 s84, s100, 13
    s_add_u32 s84, s84, s15
    s_add_u32 m0, s12, 140288
    s_nop 0
    buffer_load_dwordx4 v23, s[56:59], s84 offen  lds
    s_add_u32 m0, s12, 141376
    s_add_u32 s84, s84, 1024
    buffer_load_dwordx4 v23, s[56:59], s84 offen  lds
    s_add_u32 m0, s12, 148992
    s_add_u32 s84, s84, 523264
    buffer_load_dwordx4 v23, s[56:59], s84 offen  lds
    s_add_u32 m0, s12, 150080
    s_add_u32 s84, s84, 1024
    buffer_load_dwordx4 v23, s[56:59], s84 offen  lds
    s_waitcnt vmcnt(12)
    s_barrier
    s_bfe_u32 s86, s80, 0x40000
    s_lshl_b32 s86, s86, 19
    s_add_u32 s86, s86, s78
    s_add_u32 m0, s76, 0
    s_add_u32 s84, s86, 0
    buffer_load_dwordx4 v5, s[60:63], s84 offen  lds
    s_add_u32 m0, s76, 1024
    s_add_u32 s84, s86, 16384
    buffer_load_dwordx4 v5, s[60:63], s84 offen  lds
    s_bfe_u32 s86, s80, 0x40010
    s_lshl_b32 s86, s86, 19
    s_add_u32 s86, s86, s78
    s_add_u32 m0, s76, 2048
    s_add_u32 s84, s86, 0
L_pr1:
    s_cbranch_execz L_pr5
    buffer_load_dwordx4 v5, s[60:63], s84 offen  lds
    s_add_u32 m0, s76, 3072
    s_add_u32 s84, s86, 16384
    buffer_load_dwordx4 v5, s[60:63], s84 offen  lds
    s_bfe_u32 s86, s81, 0x40000
    s_lshl_b32 s86, s86, 19
    s_add_u32 s86, s86, s78
    s_add_u32 m0, s76, 6144
    s_add_u32 s84, s86, 0
    buffer_load_dwordx4 v5, s[60:63], s84 offen  lds
    s_add_u32 m0, s76, 7168
    s_add_u32 s84, s86, 16384
    buffer_load_dwordx4 v5, s[60:63], s84 offen  lds
    s_bfe_u32 s86, s80, 0x40004
    s_lshl_b32 s86, s86, 19
    s_add_u32 s86, s86, s78
    s_add_u32 m0, s76, 8192
    s_add_u32 s84, s86, 0
    buffer_load_dwordx4 v5, s[60:63], s84 offen  lds
    s_add_u32 m0, s76, 9216
    s_add_u32 s84, s86, 16384
    buffer_load_dwordx4 v5, s[60:63], s84 offen  lds
    s_waitcnt vmcnt(8)
    s_barrier
    s_setprio 0
    v_mov_b32 v31, 0
    s_lshl_b32 s84, s43, 4
    buffer_load_dword v30, v31, s[72:75], s84 offen sc1
    s_bfe_u32 s86, s80, 0x40000
    s_lshl_b32 s86, s86, 19
    s_add_u32 s86, s86, s78
    s_add_u32 m0, s76, 40960
    s_add_u32 s84, s86, 262144
    buffer_load_dwordx4 v5, s[60:63], s84 offen  lds
    s_add_u32 m0, s76, 41984
    s_add_u32 s84, s86, 278528
    buffer_load_dwordx4 v5, s[60:63], s84 offen  lds
    s_bfe_u32 s86, s80, 0x40010
    s_lshl_b32 s86, s86, 19
    s_add_u32 s86, s86, s78
    s_add_u32 m0, s76, 43008
    s_add_u32 s84, s86, 262144
    buffer_load_dwordx4 v5, s[60:63], s84 offen  lds
    s_add_u32 m0, s76, 44032
    s_add_u32 s84, s86, 278528
    buffer_load_dwordx4 v5, s[60:63], s84 offen  lds
    s_bfe_u32 s86, s81, 0x40000
    s_lshl_b32 s86, s86, 19
    s_add_u32 s86, s86, s78
    s_add_u32 m0, s76, 47104
    s_add_u32 s84, s86, 262144
    buffer_load_dwordx4 v5, s[60:63], s84 offen  lds
    s_add_u32 m0, s76, 48128
    s_add_u32 s84, s86, 278528
    buffer_load_dwordx4 v5, s[60:63], s84 offen  lds
    s_bfe_u32 s86, s80, 0x40004
    s_lshl_b32 s86, s86, 19
    s_add_u32 s86, s86, s78
    s_add_u32 m0, s76, 49152
    s_add_u32 s84, s86, 262144
    buffer_load_dwordx4 v5, s[60:63], s84 offen  lds
    s_add_u32 m0, s76, 50176
    s_add_u32 s84, s86, 278528
    buffer_load_dwordx4 v5, s[60:63], s84 offen  lds
    s_bfe_u32 s86, s80, 0x40008
    s_lshl_b32 s86, s86, 19
    s_add_u32 s86, s86, s78
    s_add_u32 m0, s76, 4096
    s_add_u32 s84, s86, 0
    buffer_load_dwordx4 v5, s[60:63], s84 offen  lds
    s_add_u32 m0, s76, 5120
    s_add_u32 s84, s86, 16384
    buffer_load_dwordx4 v5, s[60:63], s84 offen  lds
    s_add_u32 m0, s76, 45056
    s_add_u32 s84, s86, 262144
    buffer_load_dwordx4 v5, s[60:63], s84 offen  lds
    s_add_u32 m0, s76, 46080
    s_add_u32 s84, s86, 278528
    buffer_load_dwordx4 v5, s[60:63], s84 offen  lds
    s_waitcnt vmcnt(10)
    ds_read_b64_tr_b16 v[128:129], v1 offset:0
    ds_read_b64_tr_b16 v[130:131], v1 offset:1024
    ds_read_b64_tr_b16 v[132:133], v2 offset:0
    ds_read_b64_tr_b16 v[134:135], v2 offset:1024
    ds_read_b64_tr_b16 v[136:137], v3 offset:0
    ds_read_b64_tr_b16 v[138:139], v3 offset:1024
    ds_read_b64_tr_b16 v[140:141], v4 offset:0
    ds_read_b64_tr_b16 v[142:143], v4 offset:1024
    s_waitcnt lgkmcnt(0)
    s_bfe_u32 s86, s80, 0x4000c
    s_lshl_b32 s86, s86, 19
    s_add_u32 s86, s86, s78
    s_add_u32 m0, s76, 0
    s_add_u32 s84, s86, 0
    buffer_load_dwordx4 v5, s[60:63], s84 offen  lds
    s_add_u32 m0, s76, 1024
    s_add_u32 s84, s86, 16384
    buffer_load_dwordx4 v5, s[60:63], s84 offen  lds
    s_add_u32 m0, s76, 40960
    s_add_u32 s84, s86, 262144
    buffer_load_dwordx4 v5, s[60:63], s84 offen  lds
    s_add_u32 m0, s76, 41984
    s_add_u32 s84, s86, 278528
    buffer_load_dwordx4 v5, s[60:63], s84 offen  lds
    s_waitcnt vmcnt(12)
    ds_read_b64_tr_b16 v[192:193], v1 offset:2048
    ds_read_b64_tr_b16 v[194:195], v1 offset:3072
    ds_read_b64_tr_b16 v[196:197], v2 offset:2048
    ds_read_b64_tr_b16 v[198:199], v2 offset:3072
    ds_read_b64_tr_b16 v[200:201], v3 offset:2048
    ds_read_b64_tr_b16 v[202:203], v3 offset:3072
    ds_read_b64_tr_b16 v[204:205], v4 offset:2048
    ds_read_b64_tr_b16 v[206:207], v4 offset:3072
    s_waitcnt lgkmcnt(0)
    s_bfe_u32 s86, s80, 0x40014
    s_lshl_b32 s86, s86, 19
    s_add_u32 s86, s86, s78
    s_add_u32 m0, s76, 2048
    s_add_u32 s84, s86, 0
    buffer_load_dwordx4 v5, s[60:63], s84 offen  lds
    s_add_u32 m0, s76, 3072
    s_add_u32 s84, s86, 16384
    buffer_load_dwordx4 v5, s[60:63], s84 offen  lds
    s_add_u32 m0, s76, 43008
    s_add_u32 s84, s86, 262144
    buffer_load_dwordx4 v5, s[60:63], s84 offen  lds
    s_add_u32 m0, s76, 44032
    s_add_u32 s84, s86, 278528
    buffer_load_dwordx4 v5, s[60:63], s84 offen  lds
    s_waitcnt vmcnt(14)
    ds_read_b64_tr_b16 v[32:33], v1 offset:6144
    ds_read_b64_tr_b16 v[34:35], v1 offset:7168
    ds_read_b64_tr_b16 v[36:37], v2 offset:6144
    ds_read_b64_tr_b16 v[38:39], v2 offset:7168
    ds_read_b64_tr_b16 v[40:41], v3 offset:6144
    ds_read_b64_tr_b16 v[42:43], v3 offset:7168
    ds_read_b64_tr_b16 v[44:45], v4 offset:6144
    ds_read_b64_tr_b16 v[46:47], v4 offset:7168
    s_waitcnt lgkmcnt(0)
    s_bfe_u32 s86, s80, 0x40018
    s_lshl_b32 s86, s86, 19
    s_add_u32 s86, s86, s78
    s_add_u32 m0, s76, 6144
    s_add_u32 s84, s86, 0
    buffer_load_dwordx4 v5, s[60:63], s84 offen  lds
    s_add_u32 m0, s76, 7168
    s_add_u32 s84, s86, 16384
    buffer_load_dwordx4 v5, s[60:63], s84 offen  lds
    s_add_u32 m0, s76, 47104
    s_add_u32 s84, s86, 262144
    buffer_load_dwordx4 v5, s[60:63], s84 offen  lds
    s_add_u32 m0, s76, 48128
    s_add_u32 s84, s86, 278528
    buffer_load_dwordx4 v5, s[60:63], s84 offen  lds
    s_waitcnt vmcnt(16)
    ds_read_b64_tr_b16 v[144:145], v1 offset:8192
    ds_read_b64_tr_b16 v[146:147], v1 offset:9216
    ds_read_b64_tr_b16 v[148:149], v2 offset:8192
    ds_read_b64_tr_b16 v[150:151], v2 offset:9216
    ds_read_b64_tr_b16 v[152:153], v3 offset:8192
    ds_read_b64_tr_b16 v[154:155], v3 offset:9216
    ds_read_b64_tr_b16 v[156:157], v4 offset:8192
    ds_read_b64_tr_b16 v[158:159], v4 offset:9216
    s_waitcnt lgkmcnt(0)
    s_bfe_u32 s86, s80, 0x4001c
    s_lshl_b32 s86, s86, 19
    s_add_u32 s86, s86, s78
    s_add_u32 m0, s76, 8192
    s_add_u32 s84, s86, 0
    buffer_load_dwordx4 v5, s[60:63], s84 offen  lds
    s_add_u32 m0, s76, 9216
    s_add_u32 s84, s86, 16384
    buffer_load_dwordx4 v5, s[60:63], s84 offen  lds
    s_add_u32 m0, s76, 49152
    s_add_u32 s84, s86, 262144
    buffer_load_dwordx4 v5, s[60:63], s84 offen  lds
    s_add_u32 m0, s76, 50176
    s_add_u32 s84, s86, 278528
    buffer_load_dwordx4 v5, s[60:63], s84 offen  lds
    s_waitcnt vmcnt(16)
    ds_read_b64_tr_b16 v[160:161], v1 offset:4096
    ds_read_b64_tr_b16 v[162:163], v1 offset:5120
    ds_read_b64_tr_b16 v[164:165], v2 offset:4096
    ds_read_b64_tr_b16 v[166:167], v2 offset:5120
    ds_read_b64_tr_b16 v[168:169], v3 offset:4096
    ds_read_b64_tr_b16 v[170:171], v3 offset:5120
    ds_read_b64_tr_b16 v[172:173], v4 offset:4096
    ds_read_b64_tr_b16 v[174:175], v4 offset:5120
    s_waitcnt lgkmcnt(0)
    s_bfe_u32 s86, s81, 0x40010
    s_lshl_b32 s86, s86, 19
    s_add_u32 s86, s86, s78
    s_add_u32 m0, s76, 4096
    s_add_u32 s84, s86, 0
    buffer_load_dwordx4 v5, s[60:63], s84 offen  lds
    s_add_u32 m0, s76, 5120
    s_add_u32 s84, s86, 16384
    buffer_load_dwordx4 v5, s[60:63], s84 offen  lds
    s_add_u32 m0, s76, 45056
    s_add_u32 s84, s86, 262144
    buffer_load_dwordx4 v5, s[60:63], s84 offen  lds
    s_add_u32 m0, s76, 46080
    s_add_u32 s84, s86, 278528
    buffer_load_dwordx4 v5, s[60:63], s84 offen  lds
    s_waitcnt vmcnt(16)
    ds_read_b64_tr_b16 v[176:177], v1 offset:0
    ds_read_b64_tr_b16 v[178:179], v1 offset:1024
    ds_read_b64_tr_b16 v[180:181], v2 offset:0
    ds_read_b64_tr_b16 v[182:183], v2 offset:1024
    ds_read_b64_tr_b16 v[184:185], v3 offset:0
    ds_read_b64_tr_b16 v[186:187], v3 offset:1024
    ds_read_b64_tr_b16 v[188:189], v4 offset:0
    ds_read_b64_tr_b16 v[190:191], v4 offset:1024
    s_waitcnt lgkmcnt(0)
    s_bfe_u32 s86, s81, 0x40004
    s_lshl_b32 s86, s86, 19
    s_add_u32 s86, s86, s78
    s_add_u32 m0, s76, 0
    s_add_u32 s84, s86, 0
    buffer_load_dwordx4 v5, s[60:63], s84 offen  lds
    s_add_u32 m0, s76, 1024
    s_add_u32 s84, s86, 16384
    buffer_load_dwordx4 v5, s[60:63], s84 offen  lds
    s_add_u32 m0, s76, 40960
    s_add_u32 s84, s86, 262144
    buffer_load_dwordx4 v5, s[60:63], s84 offen  lds
    s_add_u32 m0, s76, 41984
    s_add_u32 s84, s86, 278528
    buffer_load_dwordx4 v5, s[60:63], s84 offen  lds
    s_waitcnt vmcnt(16)
    ds_read_b64_tr_b16 v[208:209], v1 offset:2048
    ds_read_b64_tr_b16 v[210:211], v1 offset:3072
    ds_read_b64_tr_b16 v[212:213], v2 offset:2048
    ds_read_b64_tr_b16 v[214:215], v2 offset:3072
    ds_read_b64_tr_b16 v[216:217], v3 offset:2048
    ds_read_b64_tr_b16 v[218:219], v3 offset:3072
    ds_read_b64_tr_b16 v[220:221], v4 offset:2048
    ds_read_b64_tr_b16 v[222:223], v4 offset:3072
    s_waitcnt lgkmcnt(0)
    s_bfe_u32 s86, s81, 0x40014
    s_lshl_b32 s86, s86, 19
    s_add_u32 s86, s86, s78
    s_add_u32 m0, s76, 2048
    s_add_u32 s84, s86, 0
    buffer_load_dwordx4 v5, s[60:63], s84 offen  lds
    s_add_u32 m0, s76, 3072
    s_add_u32 s84, s86, 16384
    buffer_load_dwordx4 v5, s[60:63], s84 offen  lds
    s_add_u32 m0, s76, 43008
    s_add_u32 s84, s86, 262144
    buffer_load_dwordx4 v5, s[60:63], s84 offen  lds
    s_add_u32 m0, s76, 44032
    s_add_u32 s84, s86, 278528
    buffer_load_dwordx4 v5, s[60:63], s84 offen  lds
    s_waitcnt vmcnt(16)
    ds_read_b64_tr_b16 v[224:225], v1 offset:6144
    ds_read_b64_tr_b16 v[226:227], v1 offset:7168
    ds_read_b64_tr_b16 v[228:229], v2 offset:6144
    ds_read_b64_tr_b16 v[230:231], v2 offset:7168
    ds_read_b64_tr_b16 v[232:233], v3 offset:6144
    ds_read_b64_tr_b16 v[234:235], v3 offset:7168
    ds_read_b64_tr_b16 v[236:237], v4 offset:6144
    ds_read_b64_tr_b16 v[238:239], v4 offset:7168
    s_waitcnt lgkmcnt(0)
    s_bfe_u32 s86, s81, 0x4000c
    s_lshl_b32 s86, s86, 19
    s_add_u32 s86, s86, s78
    s_add_u32 m0, s76, 6144
    s_add_u32 s84, s86, 0
    buffer_load_dwordx4 v5, s[60:63], s84 offen  lds
    s_add_u32 m0, s76, 7168
    s_add_u32 s84, s86, 16384
    buffer_load_dwordx4 v5, s[60:63], s84 offen  lds
    s_add_u32 m0, s76, 47104
    s_add_u32 s84, s86, 262144
    buffer_load_dwordx4 v5, s[60:63], s84 offen  lds
    s_add_u32 m0, s76, 48128
    s_add_u32 s84, s86, 278528
    buffer_load_dwordx4 v5, s[60:63], s84 offen  lds
    s_waitcnt vmcnt(16)
    ds_read_b64_tr_b16 v[240:241], v1 offset:8192
    ds_read_b64_tr_b16 v[242:243], v1 offset:9216
    ds_read_b64_tr_b16 v[244:245], v2 offset:8192
    ds_read_b64_tr_b16 v[246:247], v2 offset:9216
    ds_read_b64_tr_b16 v[248:249], v3 offset:8192
    ds_read_b64_tr_b16 v[250:251], v3 offset:9216
    ds_read_b64_tr_b16 v[252:253], v4 offset:8192
    ds_read_b64_tr_b16 v[254:255], v4 offset:9216
    s_waitcnt lgkmcnt(0)
    s_bfe_u32 s86, s81, 0x40008
    s_lshl_b32 s86, s86, 19
    s_add_u32 s86, s86, s78
    s_add_u32 m0, s76, 8192
    s_add_u32 s84, s86, 0
    buffer_load_dwordx4 v5, s[60:63], s84 offen  lds
    s_add_u32 m0, s76, 9216
    s_add_u32 s84, s86, 16384
    buffer_load_dwordx4 v5, s[60:63], s84 offen  lds
    s_add_u32 m0, s76, 49152
    s_add_u32 s84, s86, 262144
    buffer_load_dwordx4 v5, s[60:63], s84 offen  lds
    s_add_u32 m0, s76, 50176
    s_add_u32 s84, s86, 278528
    buffer_load_dwordx4 v5, s[60:63], s84 offen  lds
    s_waitcnt vmcnt(12)
    ds_read_b64_tr_b16 v[48:49], v1 offset:0
    ds_read_b64_tr_b16 v[50:51], v1 offset:1024
    ds_read_b64_tr_b16 v[52:53], v2 offset:0
    ds_read_b64_tr_b16 v[54:55], v2 offset:1024
    ds_read_b64_tr_b16 v[56:57], v3 offset:0
    ds_read_b64_tr_b16 v[58:59], v3 offset:1024
    ds_read_b64_tr_b16 v[60:61], v4 offset:0
    ds_read_b64_tr_b16 v[62:63], v4 offset:1024
    s_waitcnt lgkmcnt(0)
    s_bfe_u32 s86, s81, 0x40018
    s_lshl_b32 s86, s86, 19
    s_add_u32 s86, s86, s78
    s_add_u32 m0, s76, 0
    s_add_u32 s84, s86, 0
    buffer_load_dwordx4 v5, s[60:63], s84 offen  lds
    s_add_u32 m0, s76, 1024
    s_add_u32 s84, s86, 16384
    buffer_load_dwordx4 v5, s[60:63], s84 offen  lds
    s_add_u32 m0, s76, 40960
    s_add_u32 s84, s86, 262144
    buffer_load_dwordx4 v5, s[60:63], s84 offen  lds
    s_add_u32 m0, s76, 41984
    s_add_u32 s84, s86, 278528
    buffer_load_dwordx4 v5, s[60:63], s84 offen  lds
    s_barrier
    s_cmp_lg_u32 s7, 4
    s_cbranch_scc1 L_p3_ready
    s_mov_b32 s89, 200000
L_chk:
    v_readfirstlane_b32 s85, v30
    s_cmp_ge_u32 s85, 16
    s_cbranch_scc1 L_chk_ok
    v_mov_b32 v31, 0
    s_lshl_b32 s84, s43, 4
    buffer_load_dword v30, v31, s[72:75], s84 offen sc1
    s_waitcnt vmcnt(0)
    s_sub_u32 s89, s89, 1
    s_cmp_lg_u32 s89, 0
    s_cbranch_scc1 L_chk
L_chk_ok:
    v_lshrrev_b32 v31, 2, v0
    v_lshlrev_b32 v31, 7, v31
    v_and_b32 v7, 3, v0
    v_lshl_add_u32 v31, v7, 2, v31
    s_mov_b32 s89, 200000
L_poll:
    buffer_load_dword v7, v31, s[64:67], s88 offen sc1
    s_waitcnt vmcnt(0)
    v_cmp_eq_u32 vcc, 1, v7
    s_cmp_eq_u64 vcc, exec
    s_cbranch_scc1 L_p3_ready
    s_sleep 1
    s_sub_u32 s89, s89, 1
    s_cmp_lg_u32 s89, 0
    s_cbranch_scc1 L_poll
    s_branch L_p3_ready
L_cons:
    s_and_b32 s8, s7, 1
    s_lshr_b32 s9, s7, 1
    v_lshrrev_b32 v2, 5, v0
    v_bfe_u32 v3, v0, 2, 2
    v_and_b32 v4, 3, v0
    v_bfe_u32 v5, v0, 4, 1
    v_and_b32 v6, 31, v0
    v_lshrrev_b32 v24, 4, v0
    v_lshl_add_u32 v25, v24, 3, v3
    v_lshlrev_b32 v25, 9, v25
    v_lshl_add_u32 v26, v5, 2, v3
    v_lshl_add_u32 v25, v26, 5, v25
    v_lshl_add_u32 v25, v4, 3, v25
    s_lshl_b32 s13, s9, 8
    s_add_u32 s13, s13, 122880
    v_add_u32 v25, s13, v25
    v_xor_b32 v8, 0, v25
    v_xor_b32 v9, 32, v25
    v_xor_b32 v10, 64, v25
    v_xor_b32 v11, 96, v25
    v_xor_b32 v12, 128, v25
    v_xor_b32 v13, 160, v25
    v_xor_b32 v14, 192, v25
    v_xor_b32 v15, 224, v25
    s_lshl_b32 s13, s8, 12
    s_add_u32 s13, s13, 155648
    v_and_b32 v25, 15, v0
    v_lshrrev_b32 v26, 1, v25
    v_xor_b32 v26, v26, v24
    v_lshlrev_b32 v25, 7, v25
    v_add_u32 v25, s13, v25
    v_lshl_add_u32 v16, v26, 4, v25
    v_xor_b32 v17, 64, v16
    v_lshl_add_u32 v24, v5, 2, v4
    v_mul_u32_u24 v24, 1088, v24
    v_lshl_add_u32 v24, v3, 8, v24
    s_mul_i32 s13, s8, 8704
    v_add_u32 v24, s13, v24
    v_xor_b32 v25, v2, v3
    v_lshl_add_u32 v26, v25, 4, v24
    v_xor_b32 v25, 2, v25
    v_lshl_add_u32 v27, v25, 4, v24
    v_mul_u32_u24 v24, 1088, v3
    v_lshl_add_u32 v24, v2, 8, v24
    v_lshl_add_u32 v24, v5, 5, v24
    v_lshl_add_u32 v24, v4, 3, v24
    s_add_u32 s13, s13, 17408
    v_add_u32 v28, s13, v24
    v_add_u32 v29, 81920, v26
    v_add_u32 v30, 81920, v27
    v_add_u32 v31, 81920, v28
    v_mov_b32 v64, 0
    v_mov_b32 v65, 0
    v_mov_b32 v66, 0
    v_mov_b32 v67, 0
    v_mov_b32 v68, 0
    v_mov_b32 v69, 0
    v_mov_b32 v70, 0
    v_mov_b32 v71, 0
    v_mov_b32 v72, 0
    v_mov_b32 v73, 0
    v_mov_b32 v74, 0
    v_mov_b32 v75, 0
    v_mov_b32 v76, 0
    v_mov_b32 v77, 0
    v_mov_b32 v78, 0
    v_mov_b32 v79, 0
    v_mov_b32 v80, 0
    v_mov_b32 v81, 0
    v_mov_b32 v82, 0
    v_mov_b32 v83, 0
    v_mov_b32 v84, 0
    v_mov_b32 v85, 0
    v_mov_b32 v86, 0
    v_mov_b32 v87, 0
    v_mov_b32 v88, 0
    v_mov_b32 v89, 0
    v_mov_b32 v90, 0
    v_mov_b32 v91, 0
    v_mov_b32 v92, 0
    v_mov_b32 v93, 0
    v_mov_b32 v94, 0
    v_mov_b32 v95, 0
    v_mov_b32 v96, 0
    v_mov_b32 v97, 0
    v_mov_b32 v98, 0
    v_mov_b32 v99, 0
    v_mov_b32 v100, 0
    v_mov_b32 v101, 0
    v_mov_b32 v102, 0
    v_mov_b32 v103, 0
    v_mov_b32 v104, 0
    v_mov_b32 v105, 0
    v_mov_b32 v106, 0
    v_mov_b32 v107, 0
    v_mov_b32 v108, 0
    v_mov_b32 v109, 0
    v_mov_b32 v110, 0
    v_mov_b32 v111, 0
    v_mov_b32 v112, 0
    v_mov_b32 v113, 0
    v_mov_b32 v114, 0
    v_mov_b32 v115, 0
    v_mov_b32 v116, 0
    v_mov_b32 v117, 0
    v_mov_b32 v118, 0
    v_mov_b32 v119, 0
    v_mov_b32 v120, 0
    v_mov_b32 v121, 0
    v_mov_b32 v122, 0
    v_mov_b32 v123, 0
    v_mov_b32 v124, 0
    v_mov_b32 v125, 0
    v_mov_b32 v126, 0
    v_mov_b32 v127, 0
    v_mov_b32 v144, 0
    v_mov_b32 v145, 0
    v_mov_b32 v146, 0
    v_mov_b32 v147, 0
    v_mov_b32 v148, 0
    v_mov_b32 v149, 0
    v_mov_b32 v150, 0
    v_mov_b32 v151, 0
    v_mov_b32 v152, 0
    v_mov_b32 v153, 0
    v_mov_b32 v154, 0
    v_mov_b32 v155, 0
    v_mov_b32 v156, 0
    v_mov_b32 v157, 0
    v_mov_b32 v158, 0
    v_mov_b32 v159, 0
    v_mov_b32 v160, 0
    v_mov_b32 v161, 0
    v_mov_b32 v162, 0
    v_mov_b32 v163, 0
    v_mov_b32 v164, 0
    v_mov_b32 v165, 0
    v_mov_b32 v166, 0
    v_mov_b32 v167, 0
    v_mov_b32 v168, 0
    v_mov_b32 v169, 0
    v_mov_b32 v170, 0
    v_mov_b32 v171, 0
    v_mov_b32 v172, 0
    v_mov_b32 v173, 0
    v_mov_b32 v174, 0
    v_mov_b32 v175, 0
    v_mov_b32 v216, 0
    v_mov_b32 v217, 0
    v_mov_b32 v218, 0
    v_mov_b32 v219, 0
    v_mov_b32 v220, 0
    v_mov_b32 v221, 0
    v_mov_b32 v222, 0
    v_mov_b32 v223, 0
    v_mov_b32 v224, 0
    v_mov_b32 v225, 0
    v_mov_b32 v226, 0
    v_mov_b32 v227, 0
    v_mov_b32 v228, 0
    v_mov_b32 v229, 0
    v_mov_b32 v230, 0
    v_mov_b32 v231, 0
    v_mov_b32 v232, 0
    v_mov_b32 v233, 0
    v_mov_b32 v234, 0
    v_mov_b32 v235, 0
    v_mov_b32 v236, 0
    v_mov_b32 v237, 0
    v_mov_b32 v238, 0
    v_mov_b32 v239, 0
    v_mov_b32 v240, 0
    v_mov_b32 v241, 0
    v_mov_b32 v242, 0
    v_mov_b32 v243, 0
    v_mov_b32 v244, 0
    v_mov_b32 v245, 0
    v_mov_b32 v246, 0
    v_mov_b32 v247, 0
    s_waitcnt lgkmcnt(0)
    s_mov_b32 s64, s40
    s_mov_b32 s65, s41
    s_mov_b32 s66, 11534336
    s_mov_b32 s67, 0x20000
    s_mov_b32 s68, s36
    s_mov_b32 s69, s37
    s_mov_b32 s70, 2097152
    s_mov_b32 s71, 0x20000
    s_mov_b32 s72, s38
    s_mov_b32 s73, s39
    s_mov_b32 s74, 256
    s_mov_b32 s75, 0x20000
    s_lshl_b32 s43, s3, 3
    s_add_u32 s43, s43, s5
    s_lshl_b32 s88, s43, 11
    s_add_u32 s88, s88, 8388608
    s_cmp_eq_u32 s3, 0
    s_cselect_b32 s60, s24, s34
    s_cselect_b32 s61, s25, s35
    s_mov_b32 s62, 8388608
    s_mov_b32 s63, 0x20000
    s_lshl_b32 s12, s4, 2
    s_add_u32 s12, s12, s6
    s_lshl_b32 s89, s12, 1
    s_lshl_b32 s12, s12, 7
    s_add_u32 s12, s12, s88
    s_cmp_lg_u32 s7, 0
    s_cbranch_scc1 L_noinit
    v_lshlrev_b32 v24, 2, v0
    v_mov_b32 v25, 0
    v_mov_b32 v1, 1
    s_mov_b64 exec, 15
    buffer_store_dword v25, v24, s[64:67], s12 offen sc1
    s_mov_b64 exec, -1
L_noinit:
    s_lshl_b32 s23, s6, 1
    s_and_b32 s13, s4, 1
    s_add_u32 s23, s23, s13
    s_add_u32 s23, s23, 3
    s_cmp_eq_u32 s7, 0
    s_cselect_b32 s23, s23, 63
    s_mov_b32 s11, 0
    s_mov_b64 exec, 0
    s_cmp_eq_u32 s7, 0
    s_cbranch_scc1 L_pr0
    s_cmp_eq_u32 s7, 1
    s_cbranch_scc1 L_pr1
    s_cmp_eq_u32 s7, 2
    s_cbranch_scc1 L_pr2
    s_branch L_pr3
L_prdone:
    s_mov_b64 exec, -1
    s_barrier
    ds_read_b128 v[128:131], v16 offset:0
    ds_read_b128 v[132:135], v16 offset:2048
    ds_read_b64_tr_b16 v[184:185], v8 offset:0
    ds_read_b64_tr_b16 v[186:187], v8 offset:2048
    ds_read_b64_tr_b16 v[188:189], v9 offset:0
    ds_read_b64_tr_b16 v[190:191], v9 offset:2048
    ds_read_b64_tr_b16 v[192:193], v10 offset:0
    ds_read_b64_tr_b16 v[194:195], v10 offset:2048
    ds_read_b64_tr_b16 v[196:197], v11 offset:0
    ds_read_b64_tr_b16 v[198:199], v11 offset:2048
    ds_read_b64_tr_b16 v[200:201], v12 offset:0
    ds_read_b64_tr_b16 v[202:203], v12 offset:2048
    ds_read_b64_tr_b16 v[204:205], v13 offset:0
    ds_read_b64_tr_b16 v[206:207], v13 offset:2048
    ds_read_b64_tr_b16 v[208:209], v14 offset:0
    ds_read_b64_tr_b16 v[210:211], v14 offset:2048
    ds_read_b64_tr_b16 v[212:213], v15 offset:0
    ds_read_b64_tr_b16 v[214:215], v15 offset:2048
L_p1:
    s_waitcnt lgkmcnt(11)
    v_mfma_f32_16x16x32_bf16 v[144:147], v[184:187], v[128:131], v[144:147]
    ds_read_b128 v[136:139], v17 offset:0
    v_mfma_f32_16x16x32_bf16 v[148:151], v[184:187], v[132:135], v[148:151]
    ds_read_b64_tr_b16 v[184:185], v8 offset:16384
    ds_read_b64_tr_b16 v[186:187], v8 offset:18432
    v_mfma_f32_16x16x32_bf16 v[152:155], v[188:191], v[128:131], v[152:155]
    ds_read_b128 v[140:143], v17 offset:2048
    v_mfma_f32_16x16x32_bf16 v[156:159], v[188:191], v[132:135], v[156:159]
    ds_read_b64_tr_b16 v[188:189], v9 offset:16384
    ds_read_b64_tr_b16 v[190:191], v9 offset:18432
    s_waitcnt lgkmcnt(11)
    v_mfma_f32_16x16x32_bf16 v[160:163], v[192:195], v[128:131], v[160:163]
    v_mfma_f32_16x16x32_bf16 v[164:167], v[192:195], v[132:135], v[164:167]
    ds_read_b64_tr_b16 v[192:193], v10 offset:16384
    ds_read_b64_tr_b16 v[194:195], v10 offset:18432
    v_mfma_f32_16x16x32_bf16 v[168:171], v[196:199], v[128:131], v[168:171]
    s_add_u32 s11, s11, 1
    s_and_b32 s10, s11, 3
    v_mfma_f32_16x16x32_bf16 v[172:175], v[196:199], v[132:135], v[172:175]
    ds_read_b64_tr_b16 v[196:197], v11 offset:16384
    ds_read_b64_tr_b16 v[198:199], v11 offset:18432
    v_mfma_f32_16x16x32_bf16 v[216:219], v[200:203], v[128:131], v[216:219]
    s_mov_b32 s15, 40960
    s_cmp_eq_u32 s10, 1
    v_mfma_f32_16x16x32_bf16 v[220:223], v[200:203], v[132:135], v[220:223]
    ds_read_b64_tr_b16 v[200:201], v12 offset:16384
    ds_read_b64_tr_b16 v[202:203], v12 offset:18432
    s_waitcnt lgkmcnt(11)
    v_mfma_f32_16x16x32_bf16 v[224:227], v[204:207], v[128:131], v[224:227]
    s_cselect_b32 s15, -122880, s15
    v_mfma_f32_16x16x32_bf16 v[228:231], v[204:207], v[132:135], v[228:231]
    ds_read_b64_tr_b16 v[204:205], v13 offset:16384
    ds_read_b64_tr_b16 v[206:207], v13 offset:18432
    v_mfma_f32_16x16x32_bf16 v[232:235], v[208:211], v[128:131], v[232:235]
    s_cmp_eq_u32 s11, s23
    s_cbranch_scc1 L_init
L_init_ret:
    v_mfma_f32_16x16x32_bf16 v[236:239], v[208:211], v[132:135], v[236:239]
    ds_read_b64_tr_b16 v[208:209], v14 offset:16384
    ds_read_b64_tr_b16 v[210:211], v14 offset:18432
    v_mfma_f32_16x16x32_bf16 v[240:243], v[212:215], v[128:131], v[240:243]
    v_mfma_f32_16x16x32_bf16 v[244:247], v[212:215], v[132:135], v[244:247]
    ds_read_b64_tr_b16 v[212:213], v15 offset:16384
    ds_read_b64_tr_b16 v[214:215], v15 offset:18432
    s_waitcnt lgkmcnt(11)
    v_mfma_f32_16x16x32_bf16 v[144:147], v[184:187], v[136:139], v[144:147]
    v_add_u32 v8, s15, v8
    v_add_u32 v9, s15, v9
    v_mfma_f32_16x16x32_bf16 v[148:151], v[184:187], v[140:143], v[148:151]
    v_add_u32 v10, s15, v10
    v_add_u32 v11, s15, v11
    v_mfma_f32_16x16x32_bf16 v[152:155], v[188:191], v[136:139], v[152:155]
    v_add_u32 v12, s15, v12
    v_add_u32 v13, s15, v13
    v_mfma_f32_16x16x32_bf16 v[156:159], v[188:191], v[140:143], v[156:159]
    v_add_u32 v14, s15, v14
    v_add_u32 v15, s15, v15
    s_waitcnt lgkmcnt(10)
    v_mfma_f32_16x16x32_bf16 v[160:163], v[192:195], v[136:139], v[160:163]
    v_add_u32 v16, s15, v16
L_pr2:
    s_cbranch_execz L_pr6
    v_add_u32 v17, s15, v17
    v_mfma_f32_16x16x32_bf16 v[164:167], v[192:195], v[140:143], v[164:167]
    s_waitcnt lgkmcnt(0)
    s_barrier
    v_mfma_f32_16x16x32_bf16 v[168:171], v[196:199], v[136:139], v[168:171]
    ds_read_b128 v[128:131], v16 offset:0
    ds_read_b128 v[132:135], v16 offset:2048
    v_mfma_f32_16x16x32_bf16 v[172:175], v[196:199], v[140:143], v[172:175]
    ds_read_b64_tr_b16 v[184:185], v8 offset:0
    ds_read_b64_tr_b16 v[186:187], v8 offset:2048
    v_mfma_f32_16x16x32_bf16 v[216:219], v[200:203], v[136:139], v[216:219]
    ds_read_b64_tr_b16 v[188:189], v9 offset:0
    ds_read_b64_tr_b16 v[190:191], v9 offset:2048
    v_mfma_f32_16x16x32_bf16 v[220:223], v[200:203], v[140:143], v[220:223]
    ds_read_b64_tr_b16 v[192:193], v10 offset:0
    ds_read_b64_tr_b16 v[194:195], v10 offset:2048
    v_mfma_f32_16x16x32_bf16 v[224:227], v[204:207], v[136:139], v[224:227]
    ds_read_b64_tr_b16 v[196:197], v11 offset:0
    ds_read_b64_tr_b16 v[198:199], v11 offset:2048
    v_mfma_f32_16x16x32_bf16 v[228:231], v[204:207], v[140:143], v[228:231]
    ds_read_b64_tr_b16 v[200:201], v12 offset:0
    ds_read_b64_tr_b16 v[202:203], v12 offset:2048
    v_mfma_f32_16x16x32_bf16 v[232:235], v[208:211], v[136:139], v[232:235]
    ds_read_b64_tr_b16 v[204:205], v13 offset:0
    ds_read_b64_tr_b16 v[206:207], v13 offset:2048
    v_mfma_f32_16x16x32_bf16 v[236:239], v[208:211], v[140:143], v[236:239]
    ds_read_b64_tr_b16 v[208:209], v14 offset:0
    ds_read_b64_tr_b16 v[210:211], v14 offset:2048
    v_mfma_f32_16x16x32_bf16 v[240:243], v[212:215], v[136:139], v[240:243]
    s_cmp_lt_u32 s11, 16
    v_mfma_f32_16x16x32_bf16 v[244:247], v[212:215], v[140:143], v[244:247]
    ds_read_b64_tr_b16 v[212:213], v15 offset:0
    ds_read_b64_tr_b16 v[214:215], v15 offset:2048
    s_cbranch_scc1 L_p1
    ds_read_b128 v[184:187], v29 offset:40960
    ds_read_b128 v[188:191], v30 offset:40960
    ds_read_b128 v[192:195], v29 offset:41024
    ds_read_b128 v[196:199], v30 offset:41024
    ds_read_b128 v[200:203], v29 offset:41088
    ds_read_b128 v[204:207], v30 offset:41088
    ds_read_b128 v[208:211], v29 offset:41152
    ds_read_b128 v[212:215], v30 offset:41152
    v_mov_b32 v24, 0x3e0293ee
    v_mov_b32 v25, 0x3e0293ee
    s_nop 3
    v_pk_mul_f32 v[144:145], v[144:145], v[24:25]
    v_pk_mul_f32 v[146:147], v[146:147], v[24:25]
    v_pk_mul_f32 v[148:149], v[148:149], v[24:25]
    v_pk_mul_f32 v[150:151], v[150:151], v[24:25]
    v_pk_mul_f32 v[152:153], v[152:153], v[24:25]
    v_pk_mul_f32 v[154:155], v[154:155], v[24:25]
    v_pk_mul_f32 v[156:157], v[156:157], v[24:25]
    v_pk_mul_f32 v[158:159], v[158:159], v[24:25]
    v_pk_mul_f32 v[160:161], v[160:161], v[24:25]
    v_pk_mul_f32 v[162:163], v[162:163], v[24:25]
    v_pk_mul_f32 v[164:165], v[164:165], v[24:25]
    v_pk_mul_f32 v[166:167], v[166:167], v[24:25]
    v_pk_mul_f32 v[168:169], v[168:169], v[24:25]
    v_pk_mul_f32 v[170:171], v[170:171], v[24:25]
    v_pk_mul_f32 v[172:173], v[172:173], v[24:25]
    v_pk_mul_f32 v[174:175], v[174:175], v[24:25]
    v_pk_mul_f32 v[216:217], v[216:217], v[24:25]
    v_pk_mul_f32 v[218:219], v[218:219], v[24:25]
    v_pk_mul_f32 v[220:221], v[220:221], v[24:25]
    v_pk_mul_f32 v[222:223], v[222:223], v[24:25]
    v_pk_mul_f32 v[224:225], v[224:225], v[24:25]
    v_pk_mul_f32 v[226:227], v[226:227], v[24:25]
    v_pk_mul_f32 v[228:229], v[228:229], v[24:25]
    v_pk_mul_f32 v[230:231], v[230:231], v[24:25]
    v_pk_mul_f32 v[232:233], v[232:233], v[24:25]
    v_pk_mul_f32 v[234:235], v[234:235], v[24:25]
    v_pk_mul_f32 v[236:237], v[236:237], v[24:25]
    v_pk_mul_f32 v[238:239], v[238:239], v[24:25]
    v_pk_mul_f32 v[240:241], v[240:241], v[24:25]
    v_pk_mul_f32 v[242:243], v[242:243], v[24:25]
    v_pk_mul_f32 v[244:245], v[244:245], v[24:25]
    v_pk_mul_f32 v[246:247], v[246:247], v[24:25]
    v_cvt_pk_bf16_f32 v32, v144, v145
    v_cvt_pk_bf16_f32 v33, v146, v147
    v_cvt_pk_bf16_f32 v34, v148, v149
    v_cvt_pk_bf16_f32 v35, v150, v151
    v_cvt_pk_bf16_f32 v36, v152, v153
    v_cvt_pk_bf16_f32 v37, v154, v155
    v_cvt_pk_bf16_f32 v38, v156, v157
    v_cvt_pk_bf16_f32 v39, v158, v159
    v_permlane16_swap_b32 v32, v34
    v_permlane16_swap_b32 v33, v35
    v_cvt_pk_bf16_f32 v40, v160, v161
    v_cvt_pk_bf16_f32 v41, v162, v163
    v_cvt_pk_bf16_f32 v42, v164, v165
    v_cvt_pk_bf16_f32 v43, v166, v167
    v_permlane16_swap_b32 v36, v38
    v_permlane16_swap_b32 v37, v39
    v_cvt_pk_bf16_f32 v44, v168, v169
    v_cvt_pk_bf16_f32 v45, v170, v171
    v_cvt_pk_bf16_f32 v46, v172, v173
    v_cvt_pk_bf16_f32 v47, v174, v175
    v_permlane16_swap_b32 v40, v42
    v_permlane16_swap_b32 v41, v43
    s_waitcnt lgkmcnt(0)
    v_mfma_f32_32x32x16_bf16 v[128:143], v[184:187], v[32:35], 0
    v_cvt_pk_bf16_f32 v48, v216, v217
    v_cvt_pk_bf16_f32 v49, v218, v219
    v_cvt_pk_bf16_f32 v50, v220, v221
    v_cvt_pk_bf16_f32 v51, v222, v223
    v_permlane16_swap_b32 v44, v46
    v_permlane16_swap_b32 v45, v47
    v_mfma_f32_32x32x16_bf16 v[128:143], v[188:191], v[36:39], v[128:143]
    v_cvt_pk_bf16_f32 v52, v224, v225
    v_cvt_pk_bf16_f32 v53, v226, v227
    v_cvt_pk_bf16_f32 v54, v228, v229
    v_cvt_pk_bf16_f32 v55, v230, v231
    v_permlane16_swap_b32 v48, v50
    v_permlane16_swap_b32 v49, v51
    v_mfma_f32_32x32x16_bf16 v[128:143], v[192:195], v[40:43], v[128:143]
    v_cvt_pk_bf16_f32 v56, v232, v233
    v_cvt_pk_bf16_f32 v57, v234, v235
    v_cvt_pk_bf16_f32 v58, v236, v237
    v_cvt_pk_bf16_f32 v59, v238, v239
    v_permlane16_swap_b32 v52, v54
    v_permlane16_swap_b32 v53, v55
    v_mfma_f32_32x32x16_bf16 v[128:143], v[196:199], v[44:47], v[128:143]
    v_cvt_pk_bf16_f32 v60, v240, v241
    v_cvt_pk_bf16_f32 v61, v242, v243
    v_cvt_pk_bf16_f32 v62, v244, v245
    v_cvt_pk_bf16_f32 v63, v246, v247
    v_permlane16_swap_b32 v56, v58
    v_permlane16_swap_b32 v57, v59
    v_mfma_f32_32x32x16_bf16 v[128:143], v[200:203], v[48:51], v[128:143]
    v_permlane16_swap_b32 v60, v62
    v_permlane16_swap_b32 v61, v63
    v_mfma_f32_32x32x16_bf16 v[128:143], v[204:207], v[52:55], v[128:143]
    v_mfma_f32_32x32x16_bf16 v[128:143], v[208:211], v[56:59], v[128:143]
    v_mfma_f32_32x32x16_bf16 v[128:143], v[212:215], v[60:63], v[128:143]
    s_barrier
    ds_read_b128 v[184:187], v26 offset:0
    ds_read_b128 v[188:191], v27 offset:0
    ds_read_b128 v[192:195], v26 offset:64
    ds_read_b128 v[196:199], v27 offset:64
    ds_read_b128 v[200:203], v26 offset:128
    ds_read_b128 v[204:207], v27 offset:128
    ds_read_b128 v[208:211], v26 offset:192
    ds_read_b128 v[212:215], v27 offset:192
    ds_read_b64_tr_b16 v[216:217], v28 offset:0
    ds_read_b64_tr_b16 v[218:219], v28 offset:512
    ds_read_b64_tr_b16 v[220:221], v28 offset:64
    ds_read_b64_tr_b16 v[222:223], v28 offset:576
    ds_read_b64_tr_b16 v[224:225], v28 offset:128
    ds_read_b64_tr_b16 v[226:227], v28 offset:640
    ds_read_b64_tr_b16 v[228:229], v28 offset:192
    ds_read_b64_tr_b16 v[230:231], v28 offset:704
    v_max3_f32 v254, v128, v129, v130
    v_max3_f32 v254, v254, v131, v132
    v_max3_f32 v254, v254, v133, v134
    v_max3_f32 v254, v254, v135, v136
    v_max3_f32 v254, v254, v137, v138
    v_max3_f32 v254, v254, v139, v140
    v_max3_f32 v254, v254, v141, v142
    v_max_f32 v254, v254, v143
    v_mov_b32 v248, v254
    s_nop 1
    v_permlane32_swap_b32 v248, v254
    v_max_f32 v254, v254, v248
    v_sub_f32 v160, 0, v254
    v_sub_f32 v161, 0, v254
    v_sub_f32 v162, 0, v254
    v_sub_f32 v163, 0, v254
    v_sub_f32 v164, 0, v254
    v_sub_f32 v165, 0, v254
    v_sub_f32 v166, 0, v254
    v_sub_f32 v167, 0, v254
    v_sub_f32 v168, 0, v254
    v_sub_f32 v169, 0, v254
    v_sub_f32 v170, 0, v254
    v_sub_f32 v171, 0, v254
    v_sub_f32 v172, 0, v254
    v_sub_f32 v173, 0, v254
    v_sub_f32 v174, 0, v254
    v_sub_f32 v175, 0, v254
    v_sub_f32 v128, v128, v254
    v_sub_f32 v129, v129, v254
    v_sub_f32 v130, v130, v254
    v_sub_f32 v131, v131, v254
    v_sub_f32 v132, v132, v254
    v_sub_f32 v133, v133, v254
    v_sub_f32 v134, v134, v254
    v_sub_f32 v135, v135, v254
    v_sub_f32 v136, v136, v254
    v_sub_f32 v137, v137, v254
    v_sub_f32 v138, v138, v254
    v_sub_f32 v139, v139, v254
    v_sub_f32 v140, v140, v254
    v_sub_f32 v141, v141, v254
    v_sub_f32 v142, v142, v254
    v_sub_f32 v143, v143, v254
    v_mov_b32 v252, 0
    v_mov_b32 v253, 0
L_p2:
    s_waitcnt lgkmcnt(8)
    v_mfma_f32_32x32x16_bf16 v[144:159], v[184:187], v[32:35], v[160:175]
    ds_read_b64_tr_b16 v[232:233], v28 offset:4352
    ds_read_b64_tr_b16 v[234:235], v28 offset:4864
    v_exp_f32 v8, v128
    v_exp_f32 v9, v129
    v_mfma_f32_32x32x16_bf16 v[144:159], v[188:191], v[36:39], v[144:159]
    ds_read_b64_tr_b16 v[236:237], v28 offset:4416
    ds_read_b64_tr_b16 v[238:239], v28 offset:4928
    v_exp_f32 v10, v130
    v_cvt_pk_bf16_f32 v176, v8, v9
    v_add_f32 v252, v252, v8
    v_mfma_f32_32x32x16_bf16 v[144:159], v[192:195], v[40:43], v[144:159]
    ds_read_b64_tr_b16 v[240:241], v28 offset:4480
    ds_read_b64_tr_b16 v[242:243], v28 offset:4992
    v_exp_f32 v11, v131
    v_exp_f32 v12, v132
    v_mfma_f32_32x32x16_bf16 v[144:159], v[196:199], v[44:47], v[144:159]
    ds_read_b64_tr_b16 v[244:245], v28 offset:4544
    ds_read_b64_tr_b16 v[246:247], v28 offset:5056
    v_cvt_pk_bf16_f32 v177, v10, v11
    v_exp_f32 v13, v133
    v_add_f32 v253, v253, v9
    v_mfma_f32_32x32x16_bf16 v[144:159], v[200:203], v[48:51], v[144:159]
    v_cvt_pk_bf16_f32 v178, v12, v13
    v_exp_f32 v14, v134
    v_exp_f32 v15, v135
    v_add_f32 v252, v252, v10
    v_mfma_f32_32x32x16_bf16 v[144:159], v[204:207], v[52:55], v[144:159]
    v_cvt_pk_bf16_f32 v179, v14, v15
    v_exp_f32 v16, v136
    v_exp_f32 v17, v137
    v_add_f32 v253, v253, v11
    v_mfma_f32_32x32x16_bf16 v[144:159], v[208:211], v[56:59], v[144:159]
    v_cvt_pk_bf16_f32 v180, v16, v17
    v_exp_f32 v18, v138
    v_exp_f32 v19, v139
    v_add_f32 v252, v252, v12
    v_mfma_f32_32x32x16_bf16 v[144:159], v[212:215], v[60:63], v[144:159]
    s_waitcnt lgkmcnt(0)
    s_barrier
    v_cvt_pk_bf16_f32 v181, v18, v19
    v_add_f32 v253, v253, v13
    v_mfma_f32_32x32x16_bf16 v[64:79], v[216:219], v[176:179], v[64:79]
    ds_read_b128 v[184:187], v26 offset:40960
    ds_read_b128 v[188:191], v27 offset:40960
    v_exp_f32 v20, v140
    v_exp_f32 v21, v141
    v_mfma_f32_32x32x16_bf16 v[80:95], v[220:223], v[176:179], v[80:95]
    ds_read_b128 v[192:195], v26 offset:41024
    ds_read_b128 v[196:199], v27 offset:41024
    v_exp_f32 v22, v142
    v_cvt_pk_bf16_f32 v182, v20, v21
    v_add_f32 v252, v252, v14
    v_mfma_f32_32x32x16_bf16 v[96:111], v[224:227], v[176:179], v[96:111]
    ds_read_b128 v[200:203], v26 offset:41088
    ds_read_b128 v[204:207], v27 offset:41088
    v_exp_f32 v23, v143
    v_max3_f32 v254, v144, v145, v146
    v_cvt_pk_bf16_f32 v183, v22, v23
    v_mfma_f32_32x32x16_bf16 v[112:127], v[228:231], v[176:179], v[112:127]
    ds_read_b128 v[208:211], v26 offset:41152
    ds_read_b128 v[212:215], v27 offset:41152
    v_max3_f32 v254, v254, v147, v148
    v_add_f32 v253, v253, v15
    v_max3_f32 v254, v254, v149, v150
    v_add_f32 v252, v252, v16
    v_mfma_f32_32x32x16_bf16 v[64:79], v[232:235], v[180:183], v[64:79]
    ds_read_b64_tr_b16 v[216:217], v28 offset:40960
    ds_read_b64_tr_b16 v[218:219], v28 offset:41472
    v_max3_f32 v254, v254, v151, v152
    v_add_f32 v253, v253, v17
    v_max3_f32 v254, v254, v153, v154
    v_add_f32 v252, v252, v18
    v_mfma_f32_32x32x16_bf16 v[80:95], v[236:239], v[180:183], v[80:95]
    ds_read_b64_tr_b16 v[220:221], v28 offset:41024
    ds_read_b64_tr_b16 v[222:223], v28 offset:41536
    v_max3_f32 v254, v254, v155, v156
    v_add_f32 v253, v253, v19
    v_max3_f32 v254, v254, v157, v158
    v_add_f32 v252, v252, v20
    v_mfma_f32_32x32x16_bf16 v[96:111], v[240:243], v[180:183], v[96:111]
    ds_read_b64_tr_b16 v[224:225], v28 offset:41088
    ds_read_b64_tr_b16 v[226:227], v28 offset:41600
    v_max_f32 v254, v254, v159
    v_add_f32 v253, v253, v21
    v_add_f32 v252, v252, v22
    v_add_f32 v253, v253, v23
    v_mfma_f32_32x32x16_bf16 v[112:127], v[244:247], v[180:183], v[112:127]
    ds_read_b64_tr_b16 v[228:229], v28 offset:41152
    ds_read_b64_tr_b16 v[230:231], v28 offset:41664
    v_cmp_lt_f32 vcc, 0x41000000, v254
    s_cbranch_vccnz L_stub0
L_ret0:
    s_waitcnt lgkmcnt(8)
    v_mfma_f32_32x32x16_bf16 v[128:143], v[184:187], v[32:35], v[160:175]
    ds_read_b64_tr_b16 v[232:233], v28 offset:45312
    ds_read_b64_tr_b16 v[234:235], v28 offset:45824
    v_exp_f32 v8, v144
    v_exp_f32 v9, v145
    v_mfma_f32_32x32x16_bf16 v[128:143], v[188:191], v[36:39], v[128:143]
    ds_read_b64_tr_b16 v[236:237], v28 offset:45376
    ds_read_b64_tr_b16 v[238:239], v28 offset:45888
    v_exp_f32 v10, v146
    v_cvt_pk_bf16_f32 v176, v8, v9
    v_add_f32 v252, v252, v8
    v_mfma_f32_32x32x16_bf16 v[128:143], v[192:195], v[40:43], v[128:143]
    ds_read_b64_tr_b16 v[240:241], v28 offset:45440
    ds_read_b64_tr_b16 v[242:243], v28 offset:45952
    v_exp_f32 v11, v147
    v_exp_f32 v12, v148
    v_mfma_f32_32x32x16_bf16 v[128:143], v[196:199], v[44:47], v[128:143]
    ds_read_b64_tr_b16 v[244:245], v28 offset:45504
    ds_read_b64_tr_b16 v[246:247], v28 offset:46016
    v_cvt_pk_bf16_f32 v177, v10, v11
    v_exp_f32 v13, v149
    v_add_f32 v253, v253, v9
    v_mfma_f32_32x32x16_bf16 v[128:143], v[200:203], v[48:51], v[128:143]
    v_cvt_pk_bf16_f32 v178, v12, v13
    v_exp_f32 v14, v150
    v_exp_f32 v15, v151
    v_add_f32 v252, v252, v10
    v_mfma_f32_32x32x16_bf16 v[128:143], v[204:207], v[52:55], v[128:143]
    v_cvt_pk_bf16_f32 v179, v14, v15
    v_exp_f32 v16, v152
    v_exp_f32 v17, v153
    v_add_f32 v253, v253, v11
    v_mfma_f32_32x32x16_bf16 v[128:143], v[208:211], v[56:59], v[128:143]
    v_cvt_pk_bf16_f32 v180, v16, v17
    v_exp_f32 v18, v154
    v_exp_f32 v19, v155
    v_add_f32 v252, v252, v12
    v_mfma_f32_32x32x16_bf16 v[128:143], v[212:215], v[60:63], v[128:143]
    s_waitcnt lgkmcnt(0)
    s_barrier
    v_cvt_pk_bf16_f32 v181, v18, v19
    v_add_f32 v253, v253, v13
    v_mfma_f32_32x32x16_bf16 v[64:79], v[216:219], v[176:179], v[64:79]
    ds_read_b128 v[184:187], v29 offset:0
    ds_read_b128 v[188:191], v30 offset:0
    v_exp_f32 v20, v156
    v_exp_f32 v21, v157
    v_mfma_f32_32x32x16_bf16 v[80:95], v[220:223], v[176:179], v[80:95]
    ds_read_b128 v[192:195], v29 offset:64
    ds_read_b128 v[196:199], v30 offset:64
    v_exp_f32 v22, v158
    v_cvt_pk_bf16_f32 v182, v20, v21
    v_add_f32 v252, v252, v14
    v_mfma_f32_32x32x16_bf16 v[96:111], v[224:227], v[176:179], v[96:111]
    ds_read_b128 v[200:203], v29 offset:128
    ds_read_b128 v[204:207], v30 offset:128
    v_exp_f32 v23, v159
    v_max3_f32 v254, v128, v129, v130
    v_cvt_pk_bf16_f32 v183, v22, v23
    v_mfma_f32_32x32x16_bf16 v[112:127], v[228:231], v[176:179], v[112:127]
    ds_read_b128 v[208:211], v29 offset:192
    ds_read_b128 v[212:215], v30 offset:192
    v_max3_f32 v254, v254, v131, v132
    v_add_f32 v253, v253, v15
    v_max3_f32 v254, v254, v133, v134
    v_add_f32 v252, v252, v16
    v_mfma_f32_32x32x16_bf16 v[64:79], v[232:235], v[180:183], v[64:79]
    ds_read_b64_tr_b16 v[216:217], v31 offset:0
    ds_read_b64_tr_b16 v[218:219], v31 offset:512
    v_max3_f32 v254, v254, v135, v136
    v_add_f32 v253, v253, v17
    v_max3_f32 v254, v254, v137, v138
    v_add_f32 v252, v252, v18
    v_mfma_f32_32x32x16_bf16 v[80:95], v[236:239], v[180:183], v[80:95]
    ds_read_b64_tr_b16 v[220:221], v31 offset:64
    ds_read_b64_tr_b16 v[222:223], v31 offset:576
    v_max3_f32 v254, v254, v139, v140
    v_add_f32 v253, v253, v19
    v_max3_f32 v254, v254, v141, v142
    v_add_f32 v252, v252, v20
    v_mfma_f32_32x32x16_bf16 v[96:111], v[240:243], v[180:183], v[96:111]
    ds_read_b64_tr_b16 v[224:225], v31 offset:128
    ds_read_b64_tr_b16 v[226:227], v31 offset:640
    v_max_f32 v254, v254, v143
    v_add_f32 v253, v253, v21
    v_add_f32 v252, v252, v22
    v_add_f32 v253, v253, v23
    v_mfma_f32_32x32x16_bf16 v[112:127], v[244:247], v[180:183], v[112:127]
    ds_read_b64_tr_b16 v[228:229], v31 offset:192
    ds_read_b64_tr_b16 v[230:231], v31 offset:704
    v_cmp_lt_f32 vcc, 0x41000000, v254
    s_cbranch_vccnz L_stub1
L_ret1:
    s_waitcnt lgkmcnt(8)
    v_mfma_f32_32x32x16_bf16 v[144:159], v[184:187], v[32:35], v[160:175]
    ds_read_b64_tr_b16 v[232:233], v31 offset:4352
    ds_read_b64_tr_b16 v[234:235], v31 offset:4864
    v_exp_f32 v8, v128
    v_exp_f32 v9, v129
    v_mfma_f32_32x32x16_bf16 v[144:159], v[188:191], v[36:39], v[144:159]
    ds_read_b64_tr_b16 v[236:237], v31 offset:4416
    ds_read_b64_tr_b16 v[238:239], v31 offset:4928
    v_exp_f32 v10, v130
    v_cvt_pk_bf16_f32 v176, v8, v9
    v_add_f32 v252, v252, v8
    v_mfma_f32_32x32x16_bf16 v[144:159], v[192:195], v[40:43], v[144:159]
    ds_read_b64_tr_b16 v[240:241], v31 offset:4480
    ds_read_b64_tr_b16 v[242:243], v31 offset:4992
    v_exp_f32 v11, v131
    v_exp_f32 v12, v132
    v_mfma_f32_32x32x16_bf16 v[144:159], v[196:199], v[44:47], v[144:159]
    ds_read_b64_tr_b16 v[244:245], v31 offset:4544
    ds_read_b64_tr_b16 v[246:247], v31 offset:5056
    v_cvt_pk_bf16_f32 v177, v10, v11
    v_exp_f32 v13, v133
    v_add_f32 v253, v253, v9
    v_mfma_f32_32x32x16_bf16 v[144:159], v[200:203], v[48:51], v[144:159]
    v_cvt_pk_bf16_f32 v178, v12, v13
    v_exp_f32 v14, v134
    v_exp_f32 v15, v135
    v_add_f32 v252, v252, v10
    v_mfma_f32_32x32x16_bf16 v[144:159], v[204:207], v[52:55], v[144:159]
    v_cvt_pk_bf16_f32 v179, v14, v15
    v_exp_f32 v16, v136
    v_exp_f32 v17, v137
    v_add_f32 v253, v253, v11
    v_mfma_f32_32x32x16_bf16 v[144:159], v[208:211], v[56:59], v[144:159]
    v_cvt_pk_bf16_f32 v180, v16, v17
    v_exp_f32 v18, v138
    v_exp_f32 v19, v139
    v_add_f32 v252, v252, v12
    v_mfma_f32_32x32x16_bf16 v[144:159], v[212:215], v[60:63], v[144:159]
    s_waitcnt lgkmcnt(0)
    s_barrier
    v_cvt_pk_bf16_f32 v181, v18, v19
    v_add_f32 v253, v253, v13
    v_mfma_f32_32x32x16_bf16 v[64:79], v[216:219], v[176:179], v[64:79]
    ds_read_b128 v[184:187], v29 offset:40960
    ds_read_b128 v[188:191], v30 offset:40960
    v_exp_f32 v20, v140
    v_exp_f32 v21, v141
    v_mfma_f32_32x32x16_bf16 v[80:95], v[220:223], v[176:179], v[80:95]
    ds_read_b128 v[192:195], v29 offset:41024
    ds_read_b128 v[196:199], v30 offset:41024
    v_exp_f32 v22, v142
    v_cvt_pk_bf16_f32 v182, v20, v21
    v_add_f32 v252, v252, v14
    v_mfma_f32_32x32x16_bf16 v[96:111], v[224:227], v[176:179], v[96:111]
    ds_read_b128 v[200:203], v29 offset:41088
    ds_read_b128 v[204:207], v30 offset:41088
    v_exp_f32 v23, v143
    v_max3_f32 v254, v144, v145, v146
    v_cvt_pk_bf16_f32 v183, v22, v23
    v_mfma_f32_32x32x16_bf16 v[112:127], v[228:231], v[176:179], v[112:127]
    ds_read_b128 v[208:211], v29 offset:41152
    ds_read_b128 v[212:215], v30 offset:41152
    v_max3_f32 v254, v254, v147, v148
    v_add_f32 v253, v253, v15
    v_max3_f32 v254, v254, v149, v150
    v_add_f32 v252, v252, v16
    v_mfma_f32_32x32x16_bf16 v[64:79], v[232:235], v[180:183], v[64:79]
    ds_read_b64_tr_b16 v[216:217], v31 offset:40960
    ds_read_b64_tr_b16 v[218:219], v31 offset:41472
    v_max3_f32 v254, v254, v151, v152
    v_add_f32 v253, v253, v17
    v_max3_f32 v254, v254, v153, v154
    v_add_f32 v252, v252, v18
    v_mfma_f32_32x32x16_bf16 v[80:95], v[236:239], v[180:183], v[80:95]
    ds_read_b64_tr_b16 v[220:221], v31 offset:41024
    ds_read_b64_tr_b16 v[222:223], v31 offset:41536
    v_max3_f32 v254, v254, v155, v156
    v_add_f32 v253, v253, v19
    v_max3_f32 v254, v254, v157, v158
    v_add_f32 v252, v252, v20
    v_mfma_f32_32x32x16_bf16 v[96:111], v[240:243], v[180:183], v[96:111]
    ds_read_b64_tr_b16 v[224:225], v31 offset:41088
    ds_read_b64_tr_b16 v[226:227], v31 offset:41600
    v_max_f32 v254, v254, v159
    v_add_f32 v253, v253, v21
    v_add_f32 v252, v252, v22
    v_add_f32 v253, v253, v23
    v_mfma_f32_32x32x16_bf16 v[112:127], v[244:247], v[180:183], v[112:127]
    ds_read_b64_tr_b16 v[228:229], v31 offset:41152
    ds_read_b64_tr_b16 v[230:231], v31 offset:41664
    v_cmp_lt_f32 vcc, 0x41000000, v254
    s_cbranch_vccnz L_stub2
L_ret2:
    s_waitcnt lgkmcnt(8)
    v_mfma_f32_32x32x16_bf16 v[128:143], v[184:187], v[32:35], v[160:175]
    ds_read_b64_tr_b16 v[232:233], v31 offset:45312
    ds_read_b64_tr_b16 v[234:235], v31 offset:45824
    v_exp_f32 v8, v144
    v_exp_f32 v9, v145
    v_mfma_f32_32x32x16_bf16 v[128:143], v[188:191], v[36:39], v[128:143]
    ds_read_b64_tr_b16 v[236:237], v31 offset:45376
    ds_read_b64_tr_b16 v[238:239], v31 offset:45888
    v_exp_f32 v10, v146
    v_cvt_pk_bf16_f32 v176, v8, v9
    v_add_f32 v252, v252, v8
    v_mfma_f32_32x32x16_bf16 v[128:143], v[192:195], v[40:43], v[128:143]
    ds_read_b64_tr_b16 v[240:241], v31 offset:45440
    ds_read_b64_tr_b16 v[242:243], v31 offset:45952
    v_exp_f32 v11, v147
    v_exp_f32 v12, v148
    v_mfma_f32_32x32x16_bf16 v[128:143], v[196:199], v[44:47], v[128:143]
    ds_read_b64_tr_b16 v[244:245], v31 offset:45504
    ds_read_b64_tr_b16 v[246:247], v31 offset:46016
    v_cvt_pk_bf16_f32 v177, v10, v11
    v_exp_f32 v13, v149
    v_add_f32 v253, v253, v9
    v_mfma_f32_32x32x16_bf16 v[128:143], v[200:203], v[48:51], v[128:143]
    v_cvt_pk_bf16_f32 v178, v12, v13
    v_exp_f32 v14, v150
    v_exp_f32 v15, v151
    v_add_f32 v252, v252, v10
    v_mfma_f32_32x32x16_bf16 v[128:143], v[204:207], v[52:55], v[128:143]
    v_cvt_pk_bf16_f32 v179, v14, v15
    v_exp_f32 v16, v152
    v_exp_f32 v17, v153
    v_add_f32 v253, v253, v11
    v_mfma_f32_32x32x16_bf16 v[128:143], v[208:211], v[56:59], v[128:143]
    v_cvt_pk_bf16_f32 v180, v16, v17
    v_exp_f32 v18, v154
    v_exp_f32 v19, v155
    v_add_f32 v252, v252, v12
    v_mfma_f32_32x32x16_bf16 v[128:143], v[212:215], v[60:63], v[128:143]
    s_waitcnt lgkmcnt(0)
    s_barrier
    v_cvt_pk_bf16_f32 v181, v18, v19
    v_add_f32 v253, v253, v13
    v_mfma_f32_32x32x16_bf16 v[64:79], v[216:219], v[176:179], v[64:79]
    ds_read_b128 v[184:187], v26 offset:0
    ds_read_b128 v[188:191], v27 offset:0
    v_exp_f32 v20, v156
    v_exp_f32 v21, v157
    v_mfma_f32_32x32x16_bf16 v[80:95], v[220:223], v[176:179], v[80:95]
    ds_read_b128 v[192:195], v26 offset:64
    ds_read_b128 v[196:199], v27 offset:64
    v_exp_f32 v22, v158
    v_cvt_pk_bf16_f32 v182, v20, v21
    v_add_f32 v252, v252, v14
    v_mfma_f32_32x32x16_bf16 v[96:111], v[224:227], v[176:179], v[96:111]
    ds_read_b128 v[200:203], v26 offset:128
    ds_read_b128 v[204:207], v27 offset:128
    v_exp_f32 v23, v159
    v_max3_f32 v254, v128, v129, v130
    v_cvt_pk_bf16_f32 v183, v22, v23
    v_mfma_f32_32x32x16_bf16 v[112:127], v[228:231], v[176:179], v[112:127]
    ds_read_b128 v[208:211], v26 offset:192
    ds_read_b128 v[212:215], v27 offset:192
    v_max3_f32 v254, v254, v131, v132
    v_add_f32 v253, v253, v15
    v_max3_f32 v254, v254, v133, v134
    v_add_f32 v252, v252, v16
    v_mfma_f32_32x32x16_bf16 v[64:79], v[232:235], v[180:183], v[64:79]
    ds_read_b64_tr_b16 v[216:217], v28 offset:0
    ds_read_b64_tr_b16 v[218:219], v28 offset:512
    v_max3_f32 v254, v254, v135, v136
    v_add_f32 v253, v253, v17
    v_max3_f32 v254, v254, v137, v138
    v_add_f32 v252, v252, v18
    v_mfma_f32_32x32x16_bf16 v[80:95], v[236:239], v[180:183], v[80:95]
    ds_read_b64_tr_b16 v[220:221], v28 offset:64
    ds_read_b64_tr_b16 v[222:223], v28 offset:576
    v_max3_f32 v254, v254, v139, v140
    v_add_f32 v253, v253, v19
    v_max3_f32 v254, v254, v141, v142
    v_add_f32 v252, v252, v20
    v_mfma_f32_32x32x16_bf16 v[96:111], v[240:243], v[180:183], v[96:111]
    ds_read_b64_tr_b16 v[224:225], v28 offset:128
    ds_read_b64_tr_b16 v[226:227], v28 offset:640
    v_max_f32 v254, v254, v143
    v_add_f32 v253, v253, v21
    v_add_f32 v252, v252, v22
    v_add_f32 v253, v253, v23
    v_mfma_f32_32x32x16_bf16 v[112:127], v[244:247], v[180:183], v[112:127]
    ds_read_b64_tr_b16 v[228:229], v28 offset:192
    ds_read_b64_tr_b16 v[230:231], v28 offset:704
    v_cmp_lt_f32 vcc, 0x41000000, v254
    s_cbranch_vccnz L_stub3
L_ret3:
L_p2_mark:
    s_waitcnt lgkmcnt(8)
    v_mfma_f32_32x32x16_bf16 v[144:159], v[184:187], v[32:35], v[160:175]
    ds_read_b64_tr_b16 v[232:233], v28 offset:4352
    ds_read_b64_tr_b16 v[234:235], v28 offset:4864
    v_exp_f32 v8, v128
    v_exp_f32 v9, v129
    v_mfma_f32_32x32x16_bf16 v[144:159], v[188:191], v[36:39], v[144:159]
    ds_read_b64_tr_b16 v[236:237], v28 offset:4416
    ds_read_b64_tr_b16 v[238:239], v28 offset:4928
    v_exp_f32 v10, v130
    v_cvt_pk_bf16_f32 v176, v8, v9
    v_add_f32 v252, v252, v8
    v_mfma_f32_32x32x16_bf16 v[144:159], v[192:195], v[40:43], v[144:159]
    ds_read_b64_tr_b16 v[240:241], v28 offset:4480
    ds_read_b64_tr_b16 v[242:243], v28 offset:4992
    v_exp_f32 v11, v131
    v_exp_f32 v12, v132
    v_mfma_f32_32x32x16_bf16 v[144:159], v[196:199], v[44:47], v[144:159]
    ds_read_b64_tr_b16 v[244:245], v28 offset:4544
    ds_read_b64_tr_b16 v[246:247], v28 offset:5056
    v_cvt_pk_bf16_f32 v177, v10, v11
    v_exp_f32 v13, v133
    v_add_f32 v253, v253, v9
    v_mfma_f32_32x32x16_bf16 v[144:159], v[200:203], v[48:51], v[144:159]
    v_cvt_pk_bf16_f32 v178, v12, v13
    v_exp_f32 v14, v134
    v_exp_f32 v15, v135
    v_add_f32 v252, v252, v10
    v_mfma_f32_32x32x16_bf16 v[144:159], v[204:207], v[52:55], v[144:159]
    v_cvt_pk_bf16_f32 v179, v14, v15
    v_exp_f32 v16, v136
    v_exp_f32 v17, v137
    v_add_f32 v253, v253, v11
    v_mfma_f32_32x32x16_bf16 v[144:159], v[208:211], v[56:59], v[144:159]
    v_cvt_pk_bf16_f32 v180, v16, v17
    v_exp_f32 v18, v138
    v_exp_f32 v19, v139
    v_add_f32 v252, v252, v12
    v_mfma_f32_32x32x16_bf16 v[144:159], v[212:215], v[60:63], v[144:159]
    s_waitcnt lgkmcnt(0)
    s_barrier
    v_cvt_pk_bf16_f32 v181, v18, v19
    v_add_f32 v253, v253, v13
    v_mfma_f32_32x32x16_bf16 v[64:79], v[216:219], v[176:179], v[64:79]
    ds_read_b128 v[184:187], v26 offset:40960
    ds_read_b128 v[188:191], v27 offset:40960
    v_exp_f32 v20, v140
    v_exp_f32 v21, v141
    v_mfma_f32_32x32x16_bf16 v[80:95], v[220:223], v[176:179], v[80:95]
    ds_read_b128 v[192:195], v26 offset:41024
    ds_read_b128 v[196:199], v27 offset:41024
    v_exp_f32 v22, v142
    v_cvt_pk_bf16_f32 v182, v20, v21
    v_add_f32 v252, v252, v14
    v_mfma_f32_32x32x16_bf16 v[96:111], v[224:227], v[176:179], v[96:111]
    ds_read_b128 v[200:203], v26 offset:41088
    ds_read_b128 v[204:207], v27 offset:41088
    v_exp_f32 v23, v143
    v_max3_f32 v254, v144, v145, v146
    v_cvt_pk_bf16_f32 v183, v22, v23
    v_mfma_f32_32x32x16_bf16 v[112:127], v[228:231], v[176:179], v[112:127]
L_pr3:
    s_cbranch_execz L_prdone
    ds_read_b128 v[208:211], v26 offset:41152
    ds_read_b128 v[212:215], v27 offset:41152
    v_max3_f32 v254, v254, v147, v148
    v_add_f32 v253, v253, v15
    v_max3_f32 v254, v254, v149, v150
    v_add_f32 v252, v252, v16
    v_mfma_f32_32x32x16_bf16 v[64:79], v[232:235], v[180:183], v[64:79]
    ds_read_b64_tr_b16 v[216:217], v28 offset:40960
    ds_read_b64_tr_b16 v[218:219], v28 offset:41472
    v_max3_f32 v254, v254, v151, v152
    v_add_f32 v253, v253, v17
    v_max3_f32 v254, v254, v153, v154
    v_add_f32 v252, v252, v18
    v_mfma_f32_32x32x16_bf16 v[80:95], v[236:239], v[180:183], v[80:95]
    ds_read_b64_tr_b16 v[220:221], v28 offset:41024
    ds_read_b64_tr_b16 v[222:223], v28 offset:41536
    v_max3_f32 v254, v254, v155, v156
    v_add_f32 v253, v253, v19
    v_max3_f32 v254, v254, v157, v158
    v_add_f32 v252, v252, v20
    v_mfma_f32_32x32x16_bf16 v[96:111], v[240:243], v[180:183], v[96:111]
    ds_read_b64_tr_b16 v[224:225], v28 offset:41088
    ds_read_b64_tr_b16 v[226:227], v28 offset:41600
    v_max_f32 v254, v254, v159
    v_add_f32 v253, v253, v21
    v_add_f32 v252, v252, v22
    v_add_f32 v253, v253, v23
    v_mfma_f32_32x32x16_bf16 v[112:127], v[244:247], v[180:183], v[112:127]
    ds_read_b64_tr_b16 v[228:229], v28 offset:41152
    ds_read_b64_tr_b16 v[230:231], v28 offset:41664
    v_cmp_lt_f32 vcc, 0x41000000, v254
    s_cbranch_vccnz L_stub4
L_ret4:
    s_waitcnt lgkmcnt(8)
    v_mfma_f32_32x32x16_bf16 v[128:143], v[184:187], v[32:35], v[160:175]
    ds_read_b64_tr_b16 v[232:233], v28 offset:45312
    ds_read_b64_tr_b16 v[234:235], v28 offset:45824
    v_exp_f32 v8, v144
    v_exp_f32 v9, v145
    v_mfma_f32_32x32x16_bf16 v[128:143], v[188:191], v[36:39], v[128:143]
    ds_read_b64_tr_b16 v[236:237], v28 offset:45376
    ds_read_b64_tr_b16 v[238:239], v28 offset:45888
    v_exp_f32 v10, v146
    v_cvt_pk_bf16_f32 v176, v8, v9
    v_add_f32 v252, v252, v8
    v_mfma_f32_32x32x16_bf16 v[128:143], v[192:195], v[40:43], v[128:143]
    ds_read_b64_tr_b16 v[240:241], v28 offset:45440
    ds_read_b64_tr_b16 v[242:243], v28 offset:45952
    v_exp_f32 v11, v147
    v_exp_f32 v12, v148
    v_mfma_f32_32x32x16_bf16 v[128:143], v[196:199], v[44:47], v[128:143]
    ds_read_b64_tr_b16 v[244:245], v28 offset:45504
    ds_read_b64_tr_b16 v[246:247], v28 offset:46016
    v_cvt_pk_bf16_f32 v177, v10, v11
    v_exp_f32 v13, v149
    v_add_f32 v253, v253, v9
    v_mfma_f32_32x32x16_bf16 v[128:143], v[200:203], v[48:51], v[128:143]
    v_cvt_pk_bf16_f32 v178, v12, v13
    v_exp_f32 v14, v150
    v_exp_f32 v15, v151
    v_add_f32 v252, v252, v10
    v_mfma_f32_32x32x16_bf16 v[128:143], v[204:207], v[52:55], v[128:143]
    v_cvt_pk_bf16_f32 v179, v14, v15
    v_exp_f32 v16, v152
    v_exp_f32 v17, v153
    v_add_f32 v253, v253, v11
    v_mfma_f32_32x32x16_bf16 v[128:143], v[208:211], v[56:59], v[128:143]
    v_cvt_pk_bf16_f32 v180, v16, v17
    v_exp_f32 v18, v154
    v_exp_f32 v19, v155
    v_add_f32 v252, v252, v12
    v_mfma_f32_32x32x16_bf16 v[128:143], v[212:215], v[60:63], v[128:143]
    s_waitcnt lgkmcnt(0)
    s_barrier
    v_cvt_pk_bf16_f32 v181, v18, v19
    v_add_f32 v253, v253, v13
    v_mfma_f32_32x32x16_bf16 v[64:79], v[216:219], v[176:179], v[64:79]
    ds_read_b128 v[184:187], v29 offset:0
    ds_read_b128 v[188:191], v30 offset:0
    v_exp_f32 v20, v156
    v_exp_f32 v21, v157
    v_mfma_f32_32x32x16_bf16 v[80:95], v[220:223], v[176:179], v[80:95]
    ds_read_b128 v[192:195], v29 offset:64
    ds_read_b128 v[196:199], v30 offset:64
    v_exp_f32 v22, v158
    v_cvt_pk_bf16_f32 v182, v20, v21
    v_add_f32 v252, v252, v14
    v_mfma_f32_32x32x16_bf16 v[96:111], v[224:227], v[176:179], v[96:111]
    ds_read_b128 v[200:203], v29 offset:128
    ds_read_b128 v[204:207], v30 offset:128
    v_exp_f32 v23, v159
    v_max3_f32 v254, v128, v129, v130
    v_cvt_pk_bf16_f32 v183, v22, v23
    v_mfma_f32_32x32x16_bf16 v[112:127], v[228:231], v[176:179], v[112:127]
    ds_read_b128 v[208:211], v29 offset:192
    ds_read_b128 v[212:215], v30 offset:192
    v_max3_f32 v254, v254, v131, v132
    v_add_f32 v253, v253, v15
    v_max3_f32 v254, v254, v133, v134
    v_add_f32 v252, v252, v16
    v_mfma_f32_32x32x16_bf16 v[64:79], v[232:235], v[180:183], v[64:79]
    ds_read_b64_tr_b16 v[216:217], v31 offset:0
    ds_read_b64_tr_b16 v[218:219], v31 offset:512
    v_max3_f32 v254, v254, v135, v136
    v_add_f32 v253, v253, v17
    v_max3_f32 v254, v254, v137, v138
    v_add_f32 v252, v252, v18
    v_mfma_f32_32x32x16_bf16 v[80:95], v[236:239], v[180:183], v[80:95]
    ds_read_b64_tr_b16 v[220:221], v31 offset:64
    ds_read_b64_tr_b16 v[222:223], v31 offset:576
    v_max3_f32 v254, v254, v139, v140
    v_add_f32 v253, v253, v19
    v_max3_f32 v254, v254, v141, v142
    v_add_f32 v252, v252, v20
    v_mfma_f32_32x32x16_bf16 v[96:111], v[240:243], v[180:183], v[96:111]
    ds_read_b64_tr_b16 v[224:225], v31 offset:128
    ds_read_b64_tr_b16 v[226:227], v31 offset:640
    v_max_f32 v254, v254, v143
    v_add_f32 v253, v253, v21
    v_add_f32 v252, v252, v22
    v_add_f32 v253, v253, v23
    v_mfma_f32_32x32x16_bf16 v[112:127], v[244:247], v[180:183], v[112:127]
    ds_read_b64_tr_b16 v[228:229], v31 offset:192
    ds_read_b64_tr_b16 v[230:231], v31 offset:704
    v_cmp_lt_f32 vcc, 0x41000000, v254
    s_cbranch_vccnz L_stub5
L_ret5:
    s_waitcnt lgkmcnt(8)
    v_mfma_f32_32x32x16_bf16 v[144:159], v[184:187], v[32:35], v[160:175]
    ds_read_b64_tr_b16 v[232:233], v31 offset:4352
    ds_read_b64_tr_b16 v[234:235], v31 offset:4864
    v_exp_f32 v8, v128
    v_exp_f32 v9, v129
    v_mfma_f32_32x32x16_bf16 v[144:159], v[188:191], v[36:39], v[144:159]
    ds_read_b64_tr_b16 v[236:237], v31 offset:4416
    ds_read_b64_tr_b16 v[238:239], v31 offset:4928
    v_exp_f32 v10, v130
    v_cvt_pk_bf16_f32 v176, v8, v9
    v_add_f32 v252, v252, v8
    v_mfma_f32_32x32x16_bf16 v[144:159], v[192:195], v[40:43], v[144:159]
    ds_read_b64_tr_b16 v[240:241], v31 offset:4480
    ds_read_b64_tr_b16 v[242:243], v31 offset:4992
    v_exp_f32 v11, v131
    v_exp_f32 v12, v132
    v_mfma_f32_32x32x16_bf16 v[144:159], v[196:199], v[44:47], v[144:159]
    ds_read_b64_tr_b16 v[244:245], v31 offset:4544
    ds_read_b64_tr_b16 v[246:247], v31 offset:5056
    v_cvt_pk_bf16_f32 v177, v10, v11
    v_exp_f32 v13, v133
    v_add_f32 v253, v253, v9
    v_mfma_f32_32x32x16_bf16 v[144:159], v[200:203], v[48:51], v[144:159]
    v_cvt_pk_bf16_f32 v178, v12, v13
    v_exp_f32 v14, v134
    v_exp_f32 v15, v135
    v_add_f32 v252, v252, v10
    v_mfma_f32_32x32x16_bf16 v[144:159], v[204:207], v[52:55], v[144:159]
    v_cvt_pk_bf16_f32 v179, v14, v15
    v_exp_f32 v16, v136
    v_exp_f32 v17, v137
    v_add_f32 v253, v253, v11
    v_mfma_f32_32x32x16_bf16 v[144:159], v[208:211], v[56:59], v[144:159]
    v_cvt_pk_bf16_f32 v180, v16, v17
    v_exp_f32 v18, v138
    v_exp_f32 v19, v139
    v_add_f32 v252, v252, v12
    v_mfma_f32_32x32x16_bf16 v[144:159], v[212:215], v[60:63], v[144:159]
    s_waitcnt lgkmcnt(0)
    s_barrier
    v_cvt_pk_bf16_f32 v181, v18, v19
    v_add_f32 v253, v253, v13
    v_mfma_f32_32x32x16_bf16 v[64:79], v[216:219], v[176:179], v[64:79]
    ds_read_b128 v[184:187], v29 offset:40960
    ds_read_b128 v[188:191], v30 offset:40960
    v_exp_f32 v20, v140
    v_exp_f32 v21, v141
    v_mfma_f32_32x32x16_bf16 v[80:95], v[220:223], v[176:179], v[80:95]
    ds_read_b128 v[192:195], v29 offset:41024
    ds_read_b128 v[196:199], v30 offset:41024
    v_exp_f32 v22, v142
    v_cvt_pk_bf16_f32 v182, v20, v21
    v_add_f32 v252, v252, v14
    v_mfma_f32_32x32x16_bf16 v[96:111], v[224:227], v[176:179], v[96:111]
    ds_read_b128 v[200:203], v29 offset:41088
    ds_read_b128 v[204:207], v30 offset:41088
    v_exp_f32 v23, v143
    v_max3_f32 v254, v144, v145, v146
    v_cvt_pk_bf16_f32 v183, v22, v23
    v_mfma_f32_32x32x16_bf16 v[112:127], v[228:231], v[176:179], v[112:127]
    ds_read_b128 v[208:211], v29 offset:41152
    ds_read_b128 v[212:215], v30 offset:41152
    v_max3_f32 v254, v254, v147, v148
    v_add_f32 v253, v253, v15
    v_max3_f32 v254, v254, v149, v150
    v_add_f32 v252, v252, v16
    v_mfma_f32_32x32x16_bf16 v[64:79], v[232:235], v[180:183], v[64:79]
    ds_read_b64_tr_b16 v[216:217], v31 offset:40960
    ds_read_b64_tr_b16 v[218:219], v31 offset:41472
    v_max3_f32 v254, v254, v151, v152
    v_add_f32 v253, v253, v17
    v_max3_f32 v254, v254, v153, v154
    v_add_f32 v252, v252, v18
    v_mfma_f32_32x32x16_bf16 v[80:95], v[236:239], v[180:183], v[80:95]
    ds_read_b64_tr_b16 v[220:221], v31 offset:41024
    ds_read_b64_tr_b16 v[222:223], v31 offset:41536
    v_max3_f32 v254, v254, v155, v156
    v_add_f32 v253, v253, v19
    v_max3_f32 v254, v254, v157, v158
    v_add_f32 v252, v252, v20
    v_mfma_f32_32x32x16_bf16 v[96:111], v[240:243], v[180:183], v[96:111]
    ds_read_b64_tr_b16 v[224:225], v31 offset:41088
    ds_read_b64_tr_b16 v[226:227], v31 offset:41600
    v_max_f32 v254, v254, v159
    v_add_f32 v253, v253, v21
    v_add_f32 v252, v252, v22
    v_add_f32 v253, v253, v23
    v_mfma_f32_32x32x16_bf16 v[112:127], v[244:247], v[180:183], v[112:127]
    ds_read_b64_tr_b16 v[228:229], v31 offset:41152
    ds_read_b64_tr_b16 v[230:231], v31 offset:41664
    v_cmp_lt_f32 vcc, 0x41000000, v254
    s_cbranch_vccnz L_stub6
L_ret6:
    s_waitcnt lgkmcnt(8)
    v_mfma_f32_32x32x16_bf16 v[128:143], v[184:187], v[32:35], v[160:175]
    ds_read_b64_tr_b16 v[232:233], v31 offset:45312
    ds_read_b64_tr_b16 v[234:235], v31 offset:45824
    v_exp_f32 v8, v144
    v_exp_f32 v9, v145
    v_mfma_f32_32x32x16_bf16 v[128:143], v[188:191], v[36:39], v[128:143]
    ds_read_b64_tr_b16 v[236:237], v31 offset:45376
    ds_read_b64_tr_b16 v[238:239], v31 offset:45888
    v_exp_f32 v10, v146
    v_cvt_pk_bf16_f32 v176, v8, v9
    v_add_f32 v252, v252, v8
    v_mfma_f32_32x32x16_bf16 v[128:143], v[192:195], v[40:43], v[128:143]
    ds_read_b64_tr_b16 v[240:241], v31 offset:45440
    ds_read_b64_tr_b16 v[242:243], v31 offset:45952
    v_exp_f32 v11, v147
    v_exp_f32 v12, v148
    v_mfma_f32_32x32x16_bf16 v[128:143], v[196:199], v[44:47], v[128:143]
    ds_read_b64_tr_b16 v[244:245], v31 offset:45504
    ds_read_b64_tr_b16 v[246:247], v31 offset:46016
    v_cvt_pk_bf16_f32 v177, v10, v11
    v_exp_f32 v13, v149
    v_add_f32 v253, v253, v9
    v_mfma_f32_32x32x16_bf16 v[128:143], v[200:203], v[48:51], v[128:143]
    v_cvt_pk_bf16_f32 v178, v12, v13
    v_exp_f32 v14, v150
    v_exp_f32 v15, v151
    v_add_f32 v252, v252, v10
    v_mfma_f32_32x32x16_bf16 v[128:143], v[204:207], v[52:55], v[128:143]
    v_cvt_pk_bf16_f32 v179, v14, v15
    v_exp_f32 v16, v152
    v_exp_f32 v17, v153
    v_add_f32 v253, v253, v11
    v_mfma_f32_32x32x16_bf16 v[128:143], v[208:211], v[56:59], v[128:143]
    v_cvt_pk_bf16_f32 v180, v16, v17
    v_exp_f32 v18, v154
    v_exp_f32 v19, v155
    v_add_f32 v252, v252, v12
    v_mfma_f32_32x32x16_bf16 v[128:143], v[212:215], v[60:63], v[128:143]
    s_waitcnt lgkmcnt(0)
    s_barrier
    v_cvt_pk_bf16_f32 v181, v18, v19
    v_add_f32 v253, v253, v13
    v_mfma_f32_32x32x16_bf16 v[64:79], v[216:219], v[176:179], v[64:79]
    ds_read_b128 v[184:187], v26 offset:0
    ds_read_b128 v[188:191], v27 offset:0
    v_exp_f32 v20, v156
    v_exp_f32 v21, v157
    v_mfma_f32_32x32x16_bf16 v[80:95], v[220:223], v[176:179], v[80:95]
    ds_read_b128 v[192:195], v26 offset:64
    ds_read_b128 v[196:199], v27 offset:64
    v_exp_f32 v22, v158
    v_cvt_pk_bf16_f32 v182, v20, v21
    v_add_f32 v252, v252, v14
    v_mfma_f32_32x32x16_bf16 v[96:111], v[224:227], v[176:179], v[96:111]
    ds_read_b128 v[200:203], v26 offset:128
    ds_read_b128 v[204:207], v27 offset:128
    v_exp_f32 v23, v159
    v_max3_f32 v254, v128, v129, v130
    v_cvt_pk_bf16_f32 v183, v22, v23
    v_mfma_f32_32x32x16_bf16 v[112:127], v[228:231], v[176:179], v[112:127]
    ds_read_b128 v[208:211], v26 offset:192
    ds_read_b128 v[212:215], v27 offset:192
    v_max3_f32 v254, v254, v131, v132
    v_add_f32 v253, v253, v15
    v_max3_f32 v254, v254, v133, v134
    v_add_f32 v252, v252, v16
    v_mfma_f32_32x32x16_bf16 v[64:79], v[232:235], v[180:183], v[64:79]
    ds_read_b64_tr_b16 v[216:217], v28 offset:0
    ds_read_b64_tr_b16 v[218:219], v28 offset:512
    v_max3_f32 v254, v254, v135, v136
    v_add_f32 v253, v253, v17
    v_max3_f32 v254, v254, v137, v138
    v_add_f32 v252, v252, v18
    v_mfma_f32_32x32x16_bf16 v[80:95], v[236:239], v[180:183], v[80:95]
    ds_read_b64_tr_b16 v[220:221], v28 offset:64
    ds_read_b64_tr_b16 v[222:223], v28 offset:576
    v_max3_f32 v254, v254, v139, v140
    v_add_f32 v253, v253, v19
    v_max3_f32 v254, v254, v141, v142
    v_add_f32 v252, v252, v20
    v_mfma_f32_32x32x16_bf16 v[96:111], v[240:243], v[180:183], v[96:111]
    ds_read_b64_tr_b16 v[224:225], v28 offset:128
    ds_read_b64_tr_b16 v[226:227], v28 offset:640
    v_max_f32 v254, v254, v143
    v_add_f32 v253, v253, v21
    v_add_f32 v252, v252, v22
    v_add_f32 v253, v253, v23
    v_mfma_f32_32x32x16_bf16 v[112:127], v[244:247], v[180:183], v[112:127]
    ds_read_b64_tr_b16 v[228:229], v28 offset:192
    ds_read_b64_tr_b16 v[230:231], v28 offset:704
    v_cmp_lt_f32 vcc, 0x41000000, v254
    s_cbranch_vccnz L_stub7
L_ret7:
    s_waitcnt lgkmcnt(8)
    v_mfma_f32_32x32x16_bf16 v[144:159], v[184:187], v[32:35], v[160:175]
    ds_read_b64_tr_b16 v[232:233], v28 offset:4352
    ds_read_b64_tr_b16 v[234:235], v28 offset:4864
    v_exp_f32 v8, v128
    v_exp_f32 v9, v129
    v_mfma_f32_32x32x16_bf16 v[144:159], v[188:191], v[36:39], v[144:159]
    ds_read_b64_tr_b16 v[236:237], v28 offset:4416
    ds_read_b64_tr_b16 v[238:239], v28 offset:4928
    v_exp_f32 v10, v130
    v_cvt_pk_bf16_f32 v176, v8, v9
    v_add_f32 v252, v252, v8
    v_mfma_f32_32x32x16_bf16 v[144:159], v[192:195], v[40:43], v[144:159]
    ds_read_b64_tr_b16 v[240:241], v28 offset:4480
    ds_read_b64_tr_b16 v[242:243], v28 offset:4992
    v_exp_f32 v11, v131
    v_exp_f32 v12, v132
    v_mfma_f32_32x32x16_bf16 v[144:159], v[196:199], v[44:47], v[144:159]
    ds_read_b64_tr_b16 v[244:245], v28 offset:4544
    ds_read_b64_tr_b16 v[246:247], v28 offset:5056
    v_cvt_pk_bf16_f32 v177, v10, v11
    v_exp_f32 v13, v133
    v_add_f32 v253, v253, v9
    v_mfma_f32_32x32x16_bf16 v[144:159], v[200:203], v[48:51], v[144:159]
    v_cvt_pk_bf16_f32 v178, v12, v13
    v_exp_f32 v14, v134
    v_exp_f32 v15, v135
    v_add_f32 v252, v252, v10
    v_mfma_f32_32x32x16_bf16 v[144:159], v[204:207], v[52:55], v[144:159]
    v_cvt_pk_bf16_f32 v179, v14, v15
    v_exp_f32 v16, v136
    v_exp_f32 v17, v137
    v_add_f32 v253, v253, v11
    v_mfma_f32_32x32x16_bf16 v[144:159], v[208:211], v[56:59], v[144:159]
    v_cvt_pk_bf16_f32 v180, v16, v17
    v_exp_f32 v18, v138
    v_exp_f32 v19, v139
    v_add_f32 v252, v252, v12
    v_mfma_f32_32x32x16_bf16 v[144:159], v[212:215], v[60:63], v[144:159]
    s_waitcnt lgkmcnt(0)
    s_barrier
    v_cvt_pk_bf16_f32 v181, v18, v19
    v_add_f32 v253, v253, v13
    v_mfma_f32_32x32x16_bf16 v[64:79], v[216:219], v[176:179], v[64:79]
    ds_read_b128 v[184:187], v26 offset:40960
    ds_read_b128 v[188:191], v27 offset:40960
    v_exp_f32 v20, v140
    v_exp_f32 v21, v141
    v_mfma_f32_32x32x16_bf16 v[80:95], v[220:223], v[176:179], v[80:95]
    ds_read_b128 v[192:195], v26 offset:41024
    ds_read_b128 v[196:199], v27 offset:41024
    v_exp_f32 v22, v142
    v_cvt_pk_bf16_f32 v182, v20, v21
    v_add_f32 v252, v252, v14
    v_mfma_f32_32x32x16_bf16 v[96:111], v[224:227], v[176:179], v[96:111]
    ds_read_b128 v[200:203], v26 offset:41088
    ds_read_b128 v[204:207], v27 offset:41088
    v_exp_f32 v23, v143
    v_max3_f32 v254, v144, v145, v146
    v_cvt_pk_bf16_f32 v183, v22, v23
    v_mfma_f32_32x32x16_bf16 v[112:127], v[228:231], v[176:179], v[112:127]
    ds_read_b128 v[208:211], v26 offset:41152
    ds_read_b128 v[212:215], v27 offset:41152
    v_max3_f32 v254, v254, v147, v148
    v_add_f32 v253, v253, v15
    v_max3_f32 v254, v254, v149, v150
    v_add_f32 v252, v252, v16
    v_mfma_f32_32x32x16_bf16 v[64:79], v[232:235], v[180:183], v[64:79]
    ds_read_b64_tr_b16 v[216:217], v28 offset:40960
    ds_read_b64_tr_b16 v[218:219], v28 offset:41472
    v_max3_f32 v254, v254, v151, v152
    v_add_f32 v253, v253, v17
    v_max3_f32 v254, v254, v153, v154
    v_add_f32 v252, v252, v18
    v_mfma_f32_32x32x16_bf16 v[80:95], v[236:239], v[180:183], v[80:95]
    ds_read_b64_tr_b16 v[220:221], v28 offset:41024
    ds_read_b64_tr_b16 v[222:223], v28 offset:41536
    v_max3_f32 v254, v254, v155, v156
    v_add_f32 v253, v253, v19
    v_max3_f32 v254, v254, v157, v158
    v_add_f32 v252, v252, v20
    v_mfma_f32_32x32x16_bf16 v[96:111], v[240:243], v[180:183], v[96:111]
    ds_read_b64_tr_b16 v[224:225], v28 offset:41088
    ds_read_b64_tr_b16 v[226:227], v28 offset:41600
    v_max_f32 v254, v254, v159
    v_add_f32 v253, v253, v21
    v_add_f32 v252, v252, v22
    v_add_f32 v253, v253, v23
    v_mfma_f32_32x32x16_bf16 v[112:127], v[244:247], v[180:183], v[112:127]
    ds_read_b64_tr_b16 v[228:229], v28 offset:41152
    ds_read_b64_tr_b16 v[230:231], v28 offset:41664
    v_cmp_lt_f32 vcc, 0x41000000, v254
    s_cbranch_vccnz L_stub8
L_ret8:
    s_waitcnt lgkmcnt(8)
    v_mfma_f32_32x32x16_bf16 v[128:143], v[184:187], v[32:35], v[160:175]
    ds_read_b64_tr_b16 v[232:233], v28 offset:45312
    ds_read_b64_tr_b16 v[234:235], v28 offset:45824
    v_exp_f32 v8, v144
    v_exp_f32 v9, v145
    v_mfma_f32_32x32x16_bf16 v[128:143], v[188:191], v[36:39], v[128:143]
    ds_read_b64_tr_b16 v[236:237], v28 offset:45376
    ds_read_b64_tr_b16 v[238:239], v28 offset:45888
    v_exp_f32 v10, v146
    v_cvt_pk_bf16_f32 v176, v8, v9
    v_add_f32 v252, v252, v8
    v_mfma_f32_32x32x16_bf16 v[128:143], v[192:195], v[40:43], v[128:143]
    ds_read_b64_tr_b16 v[240:241], v28 offset:45440
    ds_read_b64_tr_b16 v[242:243], v28 offset:45952
    v_exp_f32 v11, v147
    v_exp_f32 v12, v148
    v_mfma_f32_32x32x16_bf16 v[128:143], v[196:199], v[44:47], v[128:143]
    ds_read_b64_tr_b16 v[244:245], v28 offset:45504
    ds_read_b64_tr_b16 v[246:247], v28 offset:46016
    v_cvt_pk_bf16_f32 v177, v10, v11
    v_exp_f32 v13, v149
    v_add_f32 v253, v253, v9
    v_mfma_f32_32x32x16_bf16 v[128:143], v[200:203], v[48:51], v[128:143]
    v_cvt_pk_bf16_f32 v178, v12, v13
    v_exp_f32 v14, v150
    v_exp_f32 v15, v151
    v_add_f32 v252, v252, v10
    v_mfma_f32_32x32x16_bf16 v[128:143], v[204:207], v[52:55], v[128:143]
    v_cvt_pk_bf16_f32 v179, v14, v15
    v_exp_f32 v16, v152
    v_exp_f32 v17, v153
    v_add_f32 v253, v253, v11
    v_mfma_f32_32x32x16_bf16 v[128:143], v[208:211], v[56:59], v[128:143]
    v_cvt_pk_bf16_f32 v180, v16, v17
    v_exp_f32 v18, v154
    v_exp_f32 v19, v155
    v_add_f32 v252, v252, v12
    v_mfma_f32_32x32x16_bf16 v[128:143], v[212:215], v[60:63], v[128:143]
    s_waitcnt lgkmcnt(0)
    s_barrier
    v_cvt_pk_bf16_f32 v181, v18, v19
    v_add_f32 v253, v253, v13
    v_mfma_f32_32x32x16_bf16 v[64:79], v[216:219], v[176:179], v[64:79]
    ds_read_b128 v[184:187], v29 offset:0
    ds_read_b128 v[188:191], v30 offset:0
    v_exp_f32 v20, v156
    v_exp_f32 v21, v157
    v_mfma_f32_32x32x16_bf16 v[80:95], v[220:223], v[176:179], v[80:95]
    ds_read_b128 v[192:195], v29 offset:64
    ds_read_b128 v[196:199], v30 offset:64
    v_exp_f32 v22, v158
    v_cvt_pk_bf16_f32 v182, v20, v21
    v_add_f32 v252, v252, v14
    v_mfma_f32_32x32x16_bf16 v[96:111], v[224:227], v[176:179], v[96:111]
    ds_read_b128 v[200:203], v29 offset:128
    ds_read_b128 v[204:207], v30 offset:128
    v_exp_f32 v23, v159
    v_max3_f32 v254, v128, v129, v130
    v_cvt_pk_bf16_f32 v183, v22, v23
    v_mfma_f32_32x32x16_bf16 v[112:127], v[228:231], v[176:179], v[112:127]
    ds_read_b128 v[208:211], v29 offset:192
    ds_read_b128 v[212:215], v30 offset:192
    v_max3_f32 v254, v254, v131, v132
    v_add_f32 v253, v253, v15
    v_max3_f32 v254, v254, v133, v134
    v_add_f32 v252, v252, v16
    v_mfma_f32_32x32x16_bf16 v[64:79], v[232:235], v[180:183], v[64:79]
    ds_read_b64_tr_b16 v[216:217], v31 offset:0
    ds_read_b64_tr_b16 v[218:219], v31 offset:512
    v_max3_f32 v254, v254, v135, v136
    v_add_f32 v253, v253, v17
    v_max3_f32 v254, v254, v137, v138
    v_add_f32 v252, v252, v18
    v_mfma_f32_32x32x16_bf16 v[80:95], v[236:239], v[180:183], v[80:95]
    ds_read_b64_tr_b16 v[220:221], v31 offset:64
    ds_read_b64_tr_b16 v[222:223], v31 offset:576
    v_max3_f32 v254, v254, v139, v140
    v_add_f32 v253, v253, v19
    v_max3_f32 v254, v254, v141, v142
    v_add_f32 v252, v252, v20
    v_mfma_f32_32x32x16_bf16 v[96:111], v[240:243], v[180:183], v[96:111]
    ds_read_b64_tr_b16 v[224:225], v31 offset:128
    ds_read_b64_tr_b16 v[226:227], v31 offset:640
    v_max_f32 v254, v254, v143
    v_add_f32 v253, v253, v21
    v_add_f32 v252, v252, v22
    v_add_f32 v253, v253, v23
    v_mfma_f32_32x32x16_bf16 v[112:127], v[244:247], v[180:183], v[112:127]
    ds_read_b64_tr_b16 v[228:229], v31 offset:192
    ds_read_b64_tr_b16 v[230:231], v31 offset:704
    v_cmp_lt_f32 vcc, 0x41000000, v254
    s_cbranch_vccnz L_stub9
L_ret9:
    s_waitcnt lgkmcnt(8)
    v_mfma_f32_32x32x16_bf16 v[144:159], v[184:187], v[32:35], v[160:175]
    ds_read_b64_tr_b16 v[232:233], v31 offset:4352
    ds_read_b64_tr_b16 v[234:235], v31 offset:4864
    v_exp_f32 v8, v128
    v_exp_f32 v9, v129
    v_mfma_f32_32x32x16_bf16 v[144:159], v[188:191], v[36:39], v[144:159]
    ds_read_b64_tr_b16 v[236:237], v31 offset:4416
    ds_read_b64_tr_b16 v[238:239], v31 offset:4928
    v_exp_f32 v10, v130
    v_cvt_pk_bf16_f32 v176, v8, v9
    v_add_f32 v252, v252, v8
    v_mfma_f32_32x32x16_bf16 v[144:159], v[192:195], v[40:43], v[144:159]
    ds_read_b64_tr_b16 v[240:241], v31 offset:4480
    ds_read_b64_tr_b16 v[242:243], v31 offset:4992
    v_exp_f32 v11, v131
    v_exp_f32 v12, v132
    v_mfma_f32_32x32x16_bf16 v[144:159], v[196:199], v[44:47], v[144:159]
    ds_read_b64_tr_b16 v[244:245], v31 offset:4544
    ds_read_b64_tr_b16 v[246:247], v31 offset:5056
    v_cvt_pk_bf16_f32 v177, v10, v11
    v_exp_f32 v13, v133
    v_add_f32 v253, v253, v9
    v_mfma_f32_32x32x16_bf16 v[144:159], v[200:203], v[48:51], v[144:159]
    v_cvt_pk_bf16_f32 v178, v12, v13
    v_exp_f32 v14, v134
    v_exp_f32 v15, v135
    v_add_f32 v252, v252, v10
    v_mfma_f32_32x32x16_bf16 v[144:159], v[204:207], v[52:55], v[144:159]
    v_cvt_pk_bf16_f32 v179, v14, v15
    v_exp_f32 v16, v136
    v_exp_f32 v17, v137
    v_add_f32 v253, v253, v11
    v_mfma_f32_32x32x16_bf16 v[144:159], v[208:211], v[56:59], v[144:159]
    v_cvt_pk_bf16_f32 v180, v16, v17
    v_exp_f32 v18, v138
    v_exp_f32 v19, v139
    v_add_f32 v252, v252, v12
    v_mfma_f32_32x32x16_bf16 v[144:159], v[212:215], v[60:63], v[144:159]
    s_waitcnt lgkmcnt(0)
    s_barrier
    v_cvt_pk_bf16_f32 v181, v18, v19
    v_add_f32 v253, v253, v13
    v_mfma_f32_32x32x16_bf16 v[64:79], v[216:219], v[176:179], v[64:79]
    ds_read_b128 v[184:187], v29 offset:40960
    ds_read_b128 v[188:191], v30 offset:40960
    v_exp_f32 v20, v140
    v_exp_f32 v21, v141
    v_mfma_f32_32x32x16_bf16 v[80:95], v[220:223], v[176:179], v[80:95]
    ds_read_b128 v[192:195], v29 offset:41024
    ds_read_b128 v[196:199], v30 offset:41024
    v_exp_f32 v22, v142
    v_cvt_pk_bf16_f32 v182, v20, v21
    v_add_f32 v252, v252, v14
    v_mfma_f32_32x32x16_bf16 v[96:111], v[224:227], v[176:179], v[96:111]
    ds_read_b128 v[200:203], v29 offset:41088
    ds_read_b128 v[204:207], v30 offset:41088
    v_exp_f32 v23, v143
    v_max3_f32 v254, v144, v145, v146
    v_cvt_pk_bf16_f32 v183, v22, v23
    v_mfma_f32_32x32x16_bf16 v[112:127], v[228:231], v[176:179], v[112:127]
    ds_read_b128 v[208:211], v29 offset:41152
    ds_read_b128 v[212:215], v30 offset:41152
    v_max3_f32 v254, v254, v147, v148
    v_add_f32 v253, v253, v15
    v_max3_f32 v254, v254, v149, v150
    v_add_f32 v252, v252, v16
    v_mfma_f32_32x32x16_bf16 v[64:79], v[232:235], v[180:183], v[64:79]
    ds_read_b64_tr_b16 v[216:217], v31 offset:40960
    ds_read_b64_tr_b16 v[218:219], v31 offset:41472
    v_max3_f32 v254, v254, v151, v152
    v_add_f32 v253, v253, v17
    v_max3_f32 v254, v254, v153, v154
    v_add_f32 v252, v252, v18
    v_mfma_f32_32x32x16_bf16 v[80:95], v[236:239], v[180:183], v[80:95]
    ds_read_b64_tr_b16 v[220:221], v31 offset:41024
    ds_read_b64_tr_b16 v[222:223], v31 offset:41536
    v_max3_f32 v254, v254, v155, v156
    v_add_f32 v253, v253, v19
    v_max3_f32 v254, v254, v157, v158
    v_add_f32 v252, v252, v20
    v_mfma_f32_32x32x16_bf16 v[96:111], v[240:243], v[180:183], v[96:111]
    ds_read_b64_tr_b16 v[224:225], v31 offset:41088
    ds_read_b64_tr_b16 v[226:227], v31 offset:41600
    v_max_f32 v254, v254, v159
    v_add_f32 v253, v253, v21
    v_add_f32 v252, v252, v22
    v_add_f32 v253, v253, v23
    v_mfma_f32_32x32x16_bf16 v[112:127], v[244:247], v[180:183], v[112:127]
    ds_read_b64_tr_b16 v[228:229], v31 offset:41152
    ds_read_b64_tr_b16 v[230:231], v31 offset:41664
    v_cmp_lt_f32 vcc, 0x41000000, v254
    s_cbranch_vccnz L_stub10
L_ret10:
    s_waitcnt lgkmcnt(8)
    v_mfma_f32_32x32x16_bf16 v[128:143], v[184:187], v[32:35], v[160:175]
    ds_read_b64_tr_b16 v[232:233], v31 offset:45312
    ds_read_b64_tr_b16 v[234:235], v31 offset:45824
    v_exp_f32 v8, v144
    v_exp_f32 v9, v145
    v_mfma_f32_32x32x16_bf16 v[128:143], v[188:191], v[36:39], v[128:143]
    ds_read_b64_tr_b16 v[236:237], v31 offset:45376
    ds_read_b64_tr_b16 v[238:239], v31 offset:45888
    v_exp_f32 v10, v146
    v_cvt_pk_bf16_f32 v176, v8, v9
    v_add_f32 v252, v252, v8
    v_mfma_f32_32x32x16_bf16 v[128:143], v[192:195], v[40:43], v[128:143]
    ds_read_b64_tr_b16 v[240:241], v31 offset:45440
    ds_read_b64_tr_b16 v[242:243], v31 offset:45952
    v_exp_f32 v11, v147
    v_exp_f32 v12, v148
    v_mfma_f32_32x32x16_bf16 v[128:143], v[196:199], v[44:47], v[128:143]
    ds_read_b64_tr_b16 v[244:245], v31 offset:45504
    ds_read_b64_tr_b16 v[246:247], v31 offset:46016
    v_cvt_pk_bf16_f32 v177, v10, v11
    v_exp_f32 v13, v149
    v_add_f32 v253, v253, v9
    v_mfma_f32_32x32x16_bf16 v[128:143], v[200:203], v[48:51], v[128:143]
    v_cvt_pk_bf16_f32 v178, v12, v13
    v_exp_f32 v14, v150
    v_exp_f32 v15, v151
    v_add_f32 v252, v252, v10
    v_mfma_f32_32x32x16_bf16 v[128:143], v[204:207], v[52:55], v[128:143]
    v_cvt_pk_bf16_f32 v179, v14, v15
    v_exp_f32 v16, v152
    v_exp_f32 v17, v153
    v_add_f32 v253, v253, v11
    v_mfma_f32_32x32x16_bf16 v[128:143], v[208:211], v[56:59], v[128:143]
    v_cvt_pk_bf16_f32 v180, v16, v17
    v_exp_f32 v18, v154
    v_exp_f32 v19, v155
    v_add_f32 v252, v252, v12
    v_mfma_f32_32x32x16_bf16 v[128:143], v[212:215], v[60:63], v[128:143]
    s_waitcnt lgkmcnt(0)
    s_barrier
    v_cvt_pk_bf16_f32 v181, v18, v19
    v_add_f32 v253, v253, v13
    v_mfma_f32_32x32x16_bf16 v[64:79], v[216:219], v[176:179], v[64:79]
    ds_read_b128 v[184:187], v26 offset:0
    ds_read_b128 v[188:191], v27 offset:0
    v_exp_f32 v20, v156
    v_exp_f32 v21, v157
    v_mfma_f32_32x32x16_bf16 v[80:95], v[220:223], v[176:179], v[80:95]
    ds_read_b128 v[192:195], v26 offset:64
L_pr4:
    s_cbranch_execz L_prdone
    ds_read_b128 v[196:199], v27 offset:64
    v_exp_f32 v22, v158
    v_cvt_pk_bf16_f32 v182, v20, v21
    v_add_f32 v252, v252, v14
    v_mfma_f32_32x32x16_bf16 v[96:111], v[224:227], v[176:179], v[96:111]
    ds_read_b128 v[200:203], v26 offset:128
    ds_read_b128 v[204:207], v27 offset:128
    v_exp_f32 v23, v159
    v_max3_f32 v254, v128, v129, v130
    v_cvt_pk_bf16_f32 v183, v22, v23
    v_mfma_f32_32x32x16_bf16 v[112:127], v[228:231], v[176:179], v[112:127]
    ds_read_b128 v[208:211], v26 offset:192
    ds_read_b128 v[212:215], v27 offset:192
    v_max3_f32 v254, v254, v131, v132
    v_add_f32 v253, v253, v15
    v_max3_f32 v254, v254, v133, v134
    v_add_f32 v252, v252, v16
    v_mfma_f32_32x32x16_bf16 v[64:79], v[232:235], v[180:183], v[64:79]
    ds_read_b64_tr_b16 v[216:217], v28 offset:0
    ds_read_b64_tr_b16 v[218:219], v28 offset:512
    v_max3_f32 v254, v254, v135, v136
    v_add_f32 v253, v253, v17
    v_max3_f32 v254, v254, v137, v138
    v_add_f32 v252, v252, v18
    v_mfma_f32_32x32x16_bf16 v[80:95], v[236:239], v[180:183], v[80:95]
    ds_read_b64_tr_b16 v[220:221], v28 offset:64
    ds_read_b64_tr_b16 v[222:223], v28 offset:576
    v_max3_f32 v254, v254, v139, v140
    v_add_f32 v253, v253, v19
    v_max3_f32 v254, v254, v141, v142
    v_add_f32 v252, v252, v20
    v_mfma_f32_32x32x16_bf16 v[96:111], v[240:243], v[180:183], v[96:111]
    ds_read_b64_tr_b16 v[224:225], v28 offset:128
    ds_read_b64_tr_b16 v[226:227], v28 offset:640
    v_max_f32 v254, v254, v143
    v_add_f32 v253, v253, v21
    v_add_f32 v252, v252, v22
    v_add_f32 v253, v253, v23
    v_mfma_f32_32x32x16_bf16 v[112:127], v[244:247], v[180:183], v[112:127]
    ds_read_b64_tr_b16 v[228:229], v28 offset:192
    ds_read_b64_tr_b16 v[230:231], v28 offset:704
    v_cmp_lt_f32 vcc, 0x41000000, v254
    s_cbranch_vccnz L_stub11
L_ret11:
    s_waitcnt lgkmcnt(8)
    v_mfma_f32_32x32x16_bf16 v[144:159], v[184:187], v[32:35], v[160:175]
    ds_read_b64_tr_b16 v[232:233], v28 offset:4352
    ds_read_b64_tr_b16 v[234:235], v28 offset:4864
    v_exp_f32 v8, v128
    v_exp_f32 v9, v129
    v_mfma_f32_32x32x16_bf16 v[144:159], v[188:191], v[36:39], v[144:159]
    ds_read_b64_tr_b16 v[236:237], v28 offset:4416
    ds_read_b64_tr_b16 v[238:239], v28 offset:4928
    v_exp_f32 v10, v130
    v_cvt_pk_bf16_f32 v176, v8, v9
    v_add_f32 v252, v252, v8
    v_mfma_f32_32x32x16_bf16 v[144:159], v[192:195], v[40:43], v[144:159]
    ds_read_b64_tr_b16 v[240:241], v28 offset:4480
    ds_read_b64_tr_b16 v[242:243], v28 offset:4992
    v_exp_f32 v11, v131
    v_exp_f32 v12, v132
    v_mfma_f32_32x32x16_bf16 v[144:159], v[196:199], v[44:47], v[144:159]
    ds_read_b64_tr_b16 v[244:245], v28 offset:4544
    ds_read_b64_tr_b16 v[246:247], v28 offset:5056
    v_cvt_pk_bf16_f32 v177, v10, v11
    v_exp_f32 v13, v133
    v_add_f32 v253, v253, v9
    v_mfma_f32_32x32x16_bf16 v[144:159], v[200:203], v[48:51], v[144:159]
    v_cvt_pk_bf16_f32 v178, v12, v13
    v_exp_f32 v14, v134
    v_exp_f32 v15, v135
    v_add_f32 v252, v252, v10
    v_mfma_f32_32x32x16_bf16 v[144:159], v[204:207], v[52:55], v[144:159]
    v_cvt_pk_bf16_f32 v179, v14, v15
    v_exp_f32 v16, v136
    v_exp_f32 v17, v137
    v_add_f32 v253, v253, v11
    v_mfma_f32_32x32x16_bf16 v[144:159], v[208:211], v[56:59], v[144:159]
    v_cvt_pk_bf16_f32 v180, v16, v17
    v_exp_f32 v18, v138
    v_exp_f32 v19, v139
    v_add_f32 v252, v252, v12
    v_mfma_f32_32x32x16_bf16 v[144:159], v[212:215], v[60:63], v[144:159]
    s_waitcnt lgkmcnt(0)
    s_barrier
    v_cvt_pk_bf16_f32 v181, v18, v19
    v_add_f32 v253, v253, v13
    v_mfma_f32_32x32x16_bf16 v[64:79], v[216:219], v[176:179], v[64:79]
    ds_read_b128 v[184:187], v26 offset:40960
    ds_read_b128 v[188:191], v27 offset:40960
    v_exp_f32 v20, v140
    v_exp_f32 v21, v141
    v_mfma_f32_32x32x16_bf16 v[80:95], v[220:223], v[176:179], v[80:95]
    ds_read_b128 v[192:195], v26 offset:41024
    ds_read_b128 v[196:199], v27 offset:41024
    v_exp_f32 v22, v142
    v_cvt_pk_bf16_f32 v182, v20, v21
    v_add_f32 v252, v252, v14
    v_mfma_f32_32x32x16_bf16 v[96:111], v[224:227], v[176:179], v[96:111]
    ds_read_b128 v[200:203], v26 offset:41088
    ds_read_b128 v[204:207], v27 offset:41088
    v_exp_f32 v23, v143
    v_max3_f32 v254, v144, v145, v146
    v_cvt_pk_bf16_f32 v183, v22, v23
    v_mfma_f32_32x32x16_bf16 v[112:127], v[228:231], v[176:179], v[112:127]
    ds_read_b128 v[208:211], v26 offset:41152
    ds_read_b128 v[212:215], v27 offset:41152
    v_max3_f32 v254, v254, v147, v148
    v_add_f32 v253, v253, v15
    v_max3_f32 v254, v254, v149, v150
    v_add_f32 v252, v252, v16
    v_mfma_f32_32x32x16_bf16 v[64:79], v[232:235], v[180:183], v[64:79]
    ds_read_b64_tr_b16 v[216:217], v28 offset:40960
    ds_read_b64_tr_b16 v[218:219], v28 offset:41472
    v_max3_f32 v254, v254, v151, v152
    v_add_f32 v253, v253, v17
    v_max3_f32 v254, v254, v153, v154
    v_add_f32 v252, v252, v18
    v_mfma_f32_32x32x16_bf16 v[80:95], v[236:239], v[180:183], v[80:95]
    ds_read_b64_tr_b16 v[220:221], v28 offset:41024
    ds_read_b64_tr_b16 v[222:223], v28 offset:41536
    v_max3_f32 v254, v254, v155, v156
    v_add_f32 v253, v253, v19
    v_max3_f32 v254, v254, v157, v158
    v_add_f32 v252, v252, v20
    v_mfma_f32_32x32x16_bf16 v[96:111], v[240:243], v[180:183], v[96:111]
    ds_read_b64_tr_b16 v[224:225], v28 offset:41088
    ds_read_b64_tr_b16 v[226:227], v28 offset:41600
    v_max_f32 v254, v254, v159
    v_add_f32 v253, v253, v21
    v_add_f32 v252, v252, v22
    v_add_f32 v253, v253, v23
    v_mfma_f32_32x32x16_bf16 v[112:127], v[244:247], v[180:183], v[112:127]
    ds_read_b64_tr_b16 v[228:229], v28 offset:41152
    ds_read_b64_tr_b16 v[230:231], v28 offset:41664
    v_cmp_lt_f32 vcc, 0x41000000, v254
    s_cbranch_vccnz L_stub12
L_ret12:
    s_waitcnt lgkmcnt(8)
    v_mfma_f32_32x32x16_bf16 v[128:143], v[184:187], v[32:35], v[160:175]
    ds_read_b64_tr_b16 v[232:233], v28 offset:45312
    ds_read_b64_tr_b16 v[234:235], v28 offset:45824
    v_exp_f32 v8, v144
    v_exp_f32 v9, v145
    v_mfma_f32_32x32x16_bf16 v[128:143], v[188:191], v[36:39], v[128:143]
    ds_read_b64_tr_b16 v[236:237], v28 offset:45376
    ds_read_b64_tr_b16 v[238:239], v28 offset:45888
    v_exp_f32 v10, v146
    v_cvt_pk_bf16_f32 v176, v8, v9
    v_add_f32 v252, v252, v8
    v_mfma_f32_32x32x16_bf16 v[128:143], v[192:195], v[40:43], v[128:143]
    ds_read_b64_tr_b16 v[240:241], v28 offset:45440
    ds_read_b64_tr_b16 v[242:243], v28 offset:45952
    v_exp_f32 v11, v147
    v_exp_f32 v12, v148
    v_mfma_f32_32x32x16_bf16 v[128:143], v[196:199], v[44:47], v[128:143]
    ds_read_b64_tr_b16 v[244:245], v28 offset:45504
    ds_read_b64_tr_b16 v[246:247], v28 offset:46016
    v_cvt_pk_bf16_f32 v177, v10, v11
    v_exp_f32 v13, v149
    v_add_f32 v253, v253, v9
    v_mfma_f32_32x32x16_bf16 v[128:143], v[200:203], v[48:51], v[128:143]
    v_cvt_pk_bf16_f32 v178, v12, v13
    v_exp_f32 v14, v150
    v_exp_f32 v15, v151
    v_add_f32 v252, v252, v10
    v_mfma_f32_32x32x16_bf16 v[128:143], v[204:207], v[52:55], v[128:143]
    v_cvt_pk_bf16_f32 v179, v14, v15
    v_exp_f32 v16, v152
    v_exp_f32 v17, v153
    v_add_f32 v253, v253, v11
    v_mfma_f32_32x32x16_bf16 v[128:143], v[208:211], v[56:59], v[128:143]
    v_cvt_pk_bf16_f32 v180, v16, v17
    v_exp_f32 v18, v154
    v_exp_f32 v19, v155
    v_add_f32 v252, v252, v12
    v_mfma_f32_32x32x16_bf16 v[128:143], v[212:215], v[60:63], v[128:143]
    s_waitcnt lgkmcnt(0)
    s_barrier
    v_cvt_pk_bf16_f32 v181, v18, v19
    v_add_f32 v253, v253, v13
    v_mfma_f32_32x32x16_bf16 v[64:79], v[216:219], v[176:179], v[64:79]
    ds_read_b128 v[184:187], v29 offset:0
    ds_read_b128 v[188:191], v30 offset:0
    v_exp_f32 v20, v156
    v_exp_f32 v21, v157
    v_mfma_f32_32x32x16_bf16 v[80:95], v[220:223], v[176:179], v[80:95]
    ds_read_b128 v[192:195], v29 offset:64
    ds_read_b128 v[196:199], v30 offset:64
    v_exp_f32 v22, v158
    v_cvt_pk_bf16_f32 v182, v20, v21
    v_add_f32 v252, v252, v14
    v_mfma_f32_32x32x16_bf16 v[96:111], v[224:227], v[176:179], v[96:111]
    ds_read_b128 v[200:203], v29 offset:128
    ds_read_b128 v[204:207], v30 offset:128
    v_exp_f32 v23, v159
    v_max3_f32 v254, v128, v129, v130
    v_cvt_pk_bf16_f32 v183, v22, v23
    v_mfma_f32_32x32x16_bf16 v[112:127], v[228:231], v[176:179], v[112:127]
    ds_read_b128 v[208:211], v29 offset:192
    ds_read_b128 v[212:215], v30 offset:192
    v_max3_f32 v254, v254, v131, v132
    v_add_f32 v253, v253, v15
    v_max3_f32 v254, v254, v133, v134
    v_add_f32 v252, v252, v16
    v_mfma_f32_32x32x16_bf16 v[64:79], v[232:235], v[180:183], v[64:79]
    ds_read_b64_tr_b16 v[216:217], v31 offset:0
    ds_read_b64_tr_b16 v[218:219], v31 offset:512
    v_max3_f32 v254, v254, v135, v136
    v_add_f32 v253, v253, v17
    v_max3_f32 v254, v254, v137, v138
    v_add_f32 v252, v252, v18
    v_mfma_f32_32x32x16_bf16 v[80:95], v[236:239], v[180:183], v[80:95]
    ds_read_b64_tr_b16 v[220:221], v31 offset:64
    ds_read_b64_tr_b16 v[222:223], v31 offset:576
    v_max3_f32 v254, v254, v139, v140
    v_add_f32 v253, v253, v19
    v_max3_f32 v254, v254, v141, v142
    v_add_f32 v252, v252, v20
    v_mfma_f32_32x32x16_bf16 v[96:111], v[240:243], v[180:183], v[96:111]
    ds_read_b64_tr_b16 v[224:225], v31 offset:128
    ds_read_b64_tr_b16 v[226:227], v31 offset:640
    v_max_f32 v254, v254, v143
    v_add_f32 v253, v253, v21
    v_add_f32 v252, v252, v22
    v_add_f32 v253, v253, v23
    v_mfma_f32_32x32x16_bf16 v[112:127], v[244:247], v[180:183], v[112:127]
    ds_read_b64_tr_b16 v[228:229], v31 offset:192
    ds_read_b64_tr_b16 v[230:231], v31 offset:704
    v_cmp_lt_f32 vcc, 0x41000000, v254
    s_cbranch_vccnz L_stub13
L_ret13:
    s_waitcnt lgkmcnt(8)
    v_mfma_f32_32x32x16_bf16 v[144:159], v[184:187], v[32:35], v[160:175]
    ds_read_b64_tr_b16 v[232:233], v31 offset:4352
    ds_read_b64_tr_b16 v[234:235], v31 offset:4864
    v_exp_f32 v8, v128
    v_exp_f32 v9, v129
    v_mfma_f32_32x32x16_bf16 v[144:159], v[188:191], v[36:39], v[144:159]
    ds_read_b64_tr_b16 v[236:237], v31 offset:4416
    ds_read_b64_tr_b16 v[238:239], v31 offset:4928
    v_exp_f32 v10, v130
    v_cvt_pk_bf16_f32 v176, v8, v9
    v_add_f32 v252, v252, v8
    v_mfma_f32_32x32x16_bf16 v[144:159], v[192:195], v[40:43], v[144:159]
    ds_read_b64_tr_b16 v[240:241], v31 offset:4480
    ds_read_b64_tr_b16 v[242:243], v31 offset:4992
    v_exp_f32 v11, v131
    v_exp_f32 v12, v132
    v_mfma_f32_32x32x16_bf16 v[144:159], v[196:199], v[44:47], v[144:159]
    ds_read_b64_tr_b16 v[244:245], v31 offset:4544
    ds_read_b64_tr_b16 v[246:247], v31 offset:5056
    v_cvt_pk_bf16_f32 v177, v10, v11
    v_exp_f32 v13, v133
    v_add_f32 v253, v253, v9
    v_mfma_f32_32x32x16_bf16 v[144:159], v[200:203], v[48:51], v[144:159]
    v_cvt_pk_bf16_f32 v178, v12, v13
    v_exp_f32 v14, v134
    v_exp_f32 v15, v135
    v_add_f32 v252, v252, v10
    v_mfma_f32_32x32x16_bf16 v[144:159], v[204:207], v[52:55], v[144:159]
    v_cvt_pk_bf16_f32 v179, v14, v15
    v_exp_f32 v16, v136
    v_exp_f32 v17, v137
    v_add_f32 v253, v253, v11
    v_mfma_f32_32x32x16_bf16 v[144:159], v[208:211], v[56:59], v[144:159]
    v_cvt_pk_bf16_f32 v180, v16, v17
    v_exp_f32 v18, v138
    v_exp_f32 v19, v139
    v_add_f32 v252, v252, v12
    v_mfma_f32_32x32x16_bf16 v[144:159], v[212:215], v[60:63], v[144:159]
    s_waitcnt lgkmcnt(0)
    v_cvt_pk_bf16_f32 v181, v18, v19
    v_add_f32 v253, v253, v13
    v_mfma_f32_32x32x16_bf16 v[64:79], v[216:219], v[176:179], v[64:79]
    v_exp_f32 v20, v140
    v_exp_f32 v21, v141
    v_mfma_f32_32x32x16_bf16 v[80:95], v[220:223], v[176:179], v[80:95]
    v_exp_f32 v22, v142
    v_cvt_pk_bf16_f32 v182, v20, v21
    v_add_f32 v252, v252, v14
    v_mfma_f32_32x32x16_bf16 v[96:111], v[224:227], v[176:179], v[96:111]
    v_exp_f32 v23, v143
    v_max3_f32 v254, v144, v145, v146
    v_cvt_pk_bf16_f32 v183, v22, v23
    v_mfma_f32_32x32x16_bf16 v[112:127], v[228:231], v[176:179], v[112:127]
    v_max3_f32 v254, v254, v147, v148
    v_add_f32 v253, v253, v15
    v_max3_f32 v254, v254, v149, v150
    v_add_f32 v252, v252, v16
    v_mfma_f32_32x32x16_bf16 v[64:79], v[232:235], v[180:183], v[64:79]
    ds_read_b64_tr_b16 v[216:217], v31 offset:40960
    ds_read_b64_tr_b16 v[218:219], v31 offset:41472
    v_max3_f32 v254, v254, v151, v152
    v_add_f32 v253, v253, v17
    v_max3_f32 v254, v254, v153, v154
    v_add_f32 v252, v252, v18
    v_mfma_f32_32x32x16_bf16 v[80:95], v[236:239], v[180:183], v[80:95]
    ds_read_b64_tr_b16 v[220:221], v31 offset:41024
    ds_read_b64_tr_b16 v[222:223], v31 offset:41536
    v_max3_f32 v254, v254, v155, v156
    v_add_f32 v253, v253, v19
    v_max3_f32 v254, v254, v157, v158
    v_add_f32 v252, v252, v20
    v_mfma_f32_32x32x16_bf16 v[96:111], v[240:243], v[180:183], v[96:111]
    ds_read_b64_tr_b16 v[224:225], v31 offset:41088
    ds_read_b64_tr_b16 v[226:227], v31 offset:41600
    v_max_f32 v254, v254, v159
    v_add_f32 v253, v253, v21
    v_add_f32 v252, v252, v22
    v_add_f32 v253, v253, v23
    v_mfma_f32_32x32x16_bf16 v[112:127], v[244:247], v[180:183], v[112:127]
    ds_read_b64_tr_b16 v[228:229], v31 offset:41152
    ds_read_b64_tr_b16 v[230:231], v31 offset:41664
    v_cmp_lt_f32 vcc, 0x41000000, v254
    s_cbranch_vccnz L_stub14
L_ret14:
    ds_read_b64_tr_b16 v[232:233], v31 offset:45312
    ds_read_b64_tr_b16 v[234:235], v31 offset:45824
    v_exp_f32 v8, v144
    v_exp_f32 v9, v145
    ds_read_b64_tr_b16 v[236:237], v31 offset:45376
    ds_read_b64_tr_b16 v[238:239], v31 offset:45888
    v_exp_f32 v10, v146
    v_cvt_pk_bf16_f32 v176, v8, v9
    v_add_f32 v252, v252, v8
    ds_read_b64_tr_b16 v[240:241], v31 offset:45440
    ds_read_b64_tr_b16 v[242:243], v31 offset:45952
    v_exp_f32 v11, v147
    v_exp_f32 v12, v148
    ds_read_b64_tr_b16 v[244:245], v31 offset:45504
    ds_read_b64_tr_b16 v[246:247], v31 offset:46016
    v_cvt_pk_bf16_f32 v177, v10, v11
    v_exp_f32 v13, v149
    v_add_f32 v253, v253, v9
    v_cvt_pk_bf16_f32 v178, v12, v13
    v_exp_f32 v14, v150
    v_exp_f32 v15, v151
    v_add_f32 v252, v252, v10
    v_cvt_pk_bf16_f32 v179, v14, v15
    v_exp_f32 v16, v152
    v_exp_f32 v17, v153
    v_add_f32 v253, v253, v11
    v_cvt_pk_bf16_f32 v180, v16, v17
    v_exp_f32 v18, v154
    v_exp_f32 v19, v155
    v_add_f32 v252, v252, v12
    s_waitcnt lgkmcnt(0)
    v_cvt_pk_bf16_f32 v181, v18, v19
    v_add_f32 v253, v253, v13
    v_mfma_f32_32x32x16_bf16 v[64:79], v[216:219], v[176:179], v[64:79]
    v_exp_f32 v20, v156
    v_exp_f32 v21, v157
    v_mfma_f32_32x32x16_bf16 v[80:95], v[220:223], v[176:179], v[80:95]
    v_exp_f32 v22, v158
    v_cvt_pk_bf16_f32 v182, v20, v21
    v_add_f32 v252, v252, v14
    v_mfma_f32_32x32x16_bf16 v[96:111], v[224:227], v[176:179], v[96:111]
    v_exp_f32 v23, v159
    v_add_f32 v253, v253, v15
    v_cvt_pk_bf16_f32 v183, v22, v23
    v_mfma_f32_32x32x16_bf16 v[112:127], v[228:231], v[176:179], v[112:127]
    v_add_f32 v252, v252, v16
    v_add_f32 v253, v253, v17
    v_add_f32 v252, v252, v18
    v_add_f32 v253, v253, v19
    v_mfma_f32_32x32x16_bf16 v[64:79], v[232:235], v[180:183], v[64:79]
    v_add_f32 v252, v252, v20
    v_add_f32 v253, v253, v21
    v_add_f32 v252, v252, v22
    v_add_f32 v253, v253, v23
    v_mfma_f32_32x32x16_bf16 v[80:95], v[236:239], v[180:183], v[80:95]
    v_mfma_f32_32x32x16_bf16 v[96:111], v[240:243], v[180:183], v[96:111]
    v_mfma_f32_32x32x16_bf16 v[112:127], v[244:247], v[180:183], v[112:127]
    s_setprio 3
    v_add_f32 v252, v252, v253
    v_mov_b32 v248, v252
    s_nop 1
    v_permlane32_swap_b32 v248, v252
    v_add_f32 v252, v252, v248
    v_rcp_f32 v252, v252
    v_lshlrev_b32 v24, 4, v0
    s_lshl_b32 s13, s43, 1
    s_add_u32 s13, s13, s8
    s_lshl_b32 s13, s13, 5
    s_add_u32 s13, s13, s89
    s_add_u32 s13, s13, s9
    s_lshl_b32 s13, s13, 13
    s_add_u32 s14, s13, 4096
    v_mov_b32 v253, v252
    s_nop 3
    v_pk_mul_f32 v[64:65], v[64:65], v[252:253]
    v_pk_mul_f32 v[66:67], v[66:67], v[252:253]
    v_pk_mul_f32 v[68:69], v[68:69], v[252:253]
    v_pk_mul_f32 v[70:71], v[70:71], v[252:253]
    v_cvt_pk_bf16_f32 v128, v64, v65
    v_cvt_pk_bf16_f32 v129, v66, v67
    v_cvt_pk_bf16_f32 v130, v68, v69
    v_cvt_pk_bf16_f32 v131, v70, v71
    buffer_store_dwordx4 v[128:131], v24, s[64:67], s13 offen offset:0 sc1
    v_pk_mul_f32 v[72:73], v[72:73], v[252:253]
    v_pk_mul_f32 v[74:75], v[74:75], v[252:253]
    v_pk_mul_f32 v[76:77], v[76:77], v[252:253]
    v_pk_mul_f32 v[78:79], v[78:79], v[252:253]
    v_cvt_pk_bf16_f32 v132, v72, v73
    v_cvt_pk_bf16_f32 v133, v74, v75
    v_cvt_pk_bf16_f32 v134, v76, v77
    v_cvt_pk_bf16_f32 v135, v78, v79
    buffer_store_dwordx4 v[132:135], v24, s[64:67], s13 offen offset:1024 sc1
    v_pk_mul_f32 v[80:81], v[80:81], v[252:253]
    v_pk_mul_f32 v[82:83], v[82:83], v[252:253]
    v_pk_mul_f32 v[84:85], v[84:85], v[252:253]
    v_pk_mul_f32 v[86:87], v[86:87], v[252:253]
    v_cvt_pk_bf16_f32 v136, v80, v81
    v_cvt_pk_bf16_f32 v137, v82, v83
    v_cvt_pk_bf16_f32 v138, v84, v85
    v_cvt_pk_bf16_f32 v139, v86, v87
    buffer_store_dwordx4 v[136:139], v24, s[64:67], s13 offen offset:2048 sc1
    v_pk_mul_f32 v[88:89], v[88:89], v[252:253]
    v_pk_mul_f32 v[90:91], v[90:91], v[252:253]
    v_pk_mul_f32 v[92:93], v[92:93], v[252:253]
    v_pk_mul_f32 v[94:95], v[94:95], v[252:253]
    v_cvt_pk_bf16_f32 v140, v88, v89
    v_cvt_pk_bf16_f32 v141, v90, v91
    v_cvt_pk_bf16_f32 v142, v92, v93
    v_cvt_pk_bf16_f32 v143, v94, v95
    buffer_store_dwordx4 v[140:143], v24, s[64:67], s13 offen offset:3072 sc1
    v_pk_mul_f32 v[96:97], v[96:97], v[252:253]
    v_pk_mul_f32 v[98:99], v[98:99], v[252:253]
    v_pk_mul_f32 v[100:101], v[100:101], v[252:253]
    v_pk_mul_f32 v[102:103], v[102:103], v[252:253]
    v_cvt_pk_bf16_f32 v144, v96, v97
    v_cvt_pk_bf16_f32 v145, v98, v99
    v_cvt_pk_bf16_f32 v146, v100, v101
    v_cvt_pk_bf16_f32 v147, v102, v103
    buffer_store_dwordx4 v[144:147], v24, s[64:67], s14 offen offset:0 sc1
    v_pk_mul_f32 v[104:105], v[104:105], v[252:253]
    v_pk_mul_f32 v[106:107], v[106:107], v[252:253]
    v_pk_mul_f32 v[108:109], v[108:109], v[252:253]
    v_pk_mul_f32 v[110:111], v[110:111], v[252:253]
    v_cvt_pk_bf16_f32 v148, v104, v105
    v_cvt_pk_bf16_f32 v149, v106, v107
    v_cvt_pk_bf16_f32 v150, v108, v109
    v_cvt_pk_bf16_f32 v151, v110, v111
    buffer_store_dwordx4 v[148:151], v24, s[64:67], s14 offen offset:1024 sc1
    v_pk_mul_f32 v[112:113], v[112:113], v[252:253]
    v_pk_mul_f32 v[114:115], v[114:115], v[252:253]
    v_pk_mul_f32 v[116:117], v[116:117], v[252:253]
    v_pk_mul_f32 v[118:119], v[118:119], v[252:253]
    v_cvt_pk_bf16_f32 v152, v112, v113
    v_cvt_pk_bf16_f32 v153, v114, v115
    v_cvt_pk_bf16_f32 v154, v116, v117
    v_cvt_pk_bf16_f32 v155, v118, v119
    buffer_store_dwordx4 v[152:155], v24, s[64:67], s14 offen offset:2048 sc1
    v_pk_mul_f32 v[120:121], v[120:121], v[252:253]
    v_pk_mul_f32 v[122:123], v[122:123], v[252:253]
    v_pk_mul_f32 v[124:125], v[124:125], v[252:253]
    v_pk_mul_f32 v[126:127], v[126:127], v[252:253]
    v_cvt_pk_bf16_f32 v156, v120, v121
    v_cvt_pk_bf16_f32 v157, v122, v123
    v_cvt_pk_bf16_f32 v158, v124, v125
    v_cvt_pk_bf16_f32 v159, v126, v127
    buffer_store_dwordx4 v[156:159], v24, s[64:67], s14 offen offset:3072 sc1
    s_and_b32 s84, s7, 3
    s_mul_i32 s76, s84, 10240
    s_add_u32 s76, s76, 81920
    v_lshl_add_u32 v8, v5, 2, v3
    v_lshrrev_b32 v9, 1, v8
    v_lshlrev_b32 v8, 7, v8
    v_lshl_add_u32 v8, v9, 5, v8
    v_lshl_add_u32 v8, v4, 3, v8
    v_mul_u32_u24 v9, 40960, v2
    v_add3_u32 v8, v8, v9, s76
    v_and_b32 v9, 15, v0
    v_lshl_add_u32 v9, v5, 5, v9
    v_lshlrev_b32 v9, 4, v9
    v_lshl_add_u32 v6, v2, 13, v9
    v_and_b32 v9, 7, v0
    v_lshrrev_b32 v10, 4, v0
    v_lshlrev_b32 v10, 1, v10
    v_xor_b32 v9, v9, v10
    v_lshlrev_b32 v9, 4, v9
    v_lshrrev_b32 v10, 3, v0
    v_lshl_add_u32 v5, v10, 11, v9
    v_xor_b32 v1, 0, v8
    v_xor_b32 v2, 32, v8
    v_xor_b32 v3, 64, v8
    v_xor_b32 v4, 96, v8
    s_and_b32 s85, s5, 1
    s_lshl_b32 s85, s85, 2
    s_xor_b32 s85, s85, s7
    s_lshr_b32 s86, s5, 1
    s_add_u32 s86, s86, s6
    s_and_b32 s86, s86, 3
    s_lshl_b32 s78, s85, 15
    s_lshl_b32 s84, s4, 9
    s_add_u32 s78, s78, s84
    s_lshl_b32 s84, s6, 7
    s_add_u32 s78, s78, s84
    s_lshl_b32 s79, s43, 19
    s_lshl_b32 s84, s85, 10
    s_add_u32 s79, s79, s84
    s_mov_b32 s80, 0x76543210
    s_mov_b32 s81, 0xfedcba98
    s_cmp_eq_u32 s86, 1
    s_cselect_b32 s80, 0x47650321, s80
    s_cselect_b32 s81, 0xcfed8ba9, s81
    s_cmp_eq_u32 s86, 2
    s_cselect_b32 s80, 0x54761032, s80
    s_cselect_b32 s81, 0xdcfe98ba, s81
    s_cmp_eq_u32 s86, 3
    s_cselect_b32 s80, 0x65472103, s80
    s_cselect_b32 s81, 0xedcfa98b, s81
    s_lshl_b32 s13, s7, 2
    s_add_u32 s13, s13, s12
    v_mov_b32 v24, 0
    v_mov_b32 v25, 1
    s_waitcnt vmcnt(0)
    s_mov_b64 exec, 1
    buffer_store_dword v25, v24, s[64:67], s13 offen sc1
    s_mov_b64 exec, -1
    s_barrier
    s_bfe_u32 s86, s80, 0x40000
    s_lshl_b32 s86, s86, 19
    s_add_u32 s86, s86, s78
    s_add_u32 m0, s76, 0
    s_add_u32 s84, s86, 0
    buffer_load_dwordx4 v5, s[60:63], s84 offen  lds
    s_add_u32 m0, s76, 1024
    s_add_u32 s84, s86, 16384
    buffer_load_dwordx4 v5, s[60:63], s84 offen  lds
    s_add_u32 m0, s76, 40960
    s_add_u32 s84, s86, 262144
    buffer_load_dwordx4 v5, s[60:63], s84 offen  lds
    s_add_u32 m0, s76, 41984
    s_add_u32 s84, s86, 278528
    buffer_load_dwordx4 v5, s[60:63], s84 offen  lds
    s_bfe_u32 s86, s80, 0x40010
    s_lshl_b32 s86, s86, 19
    s_add_u32 s86, s86, s78
    s_add_u32 m0, s76, 2048
    s_add_u32 s84, s86, 0
    buffer_load_dwordx4 v5, s[60:63], s84 offen  lds
    s_add_u32 m0, s76, 3072
    s_add_u32 s84, s86, 16384
    buffer_load_dwordx4 v5, s[60:63], s84 offen  lds
    s_add_u32 m0, s76, 43008
    s_add_u32 s84, s86, 262144
    buffer_load_dwordx4 v5, s[60:63], s84 offen  lds
    s_add_u32 m0, s76, 44032
    s_add_u32 s84, s86, 278528
    buffer_load_dwordx4 v5, s[60:63], s84 offen  lds
    s_bfe_u32 s86, s81, 0x40000
    s_lshl_b32 s86, s86, 19
    s_add_u32 s86, s86, s78
    s_add_u32 m0, s76, 6144
    s_add_u32 s84, s86, 0
    buffer_load_dwordx4 v5, s[60:63], s84 offen  lds
    s_add_u32 m0, s76, 7168
    s_add_u32 s84, s86, 16384
    buffer_load_dwordx4 v5, s[60:63], s84 offen  lds
    s_add_u32 m0, s76, 47104
    s_add_u32 s84, s86, 262144
    buffer_load_dwordx4 v5, s[60:63], s84 offen  lds
    s_add_u32 m0, s76, 48128
    s_add_u32 s84, s86, 278528
    buffer_load_dwordx4 v5, s[60:63], s84 offen  lds
    s_bfe_u32 s86, s80, 0x40004
    s_lshl_b32 s86, s86, 19
    s_add_u32 s86, s86, s78
    s_add_u32 m0, s76, 8192
    s_add_u32 s84, s86, 0
    buffer_load_dwordx4 v5, s[60:63], s84 offen  lds
    s_add_u32 m0, s76, 9216
    s_add_u32 s84, s86, 16384
    buffer_load_dwordx4 v5, s[60:63], s84 offen  lds
    s_add_u32 m0, s76, 49152
    s_add_u32 s84, s86, 262144
    buffer_load_dwordx4 v5, s[60:63], s84 offen  lds
    s_add_u32 m0, s76, 50176
    s_add_u32 s84, s86, 278528
    buffer_load_dwordx4 v5, s[60:63], s84 offen  lds
    s_bfe_u32 s86, s80, 0x40008
    s_lshl_b32 s86, s86, 19
    s_add_u32 s86, s86, s78
    s_add_u32 m0, s76, 4096
    s_add_u32 s84, s86, 0
    buffer_load_dwordx4 v5, s[60:63], s84 offen  lds
    s_add_u32 m0, s76, 5120
    s_add_u32 s84, s86, 16384
    buffer_load_dwordx4 v5, s[60:63], s84 offen  lds
    s_add_u32 m0, s76, 45056
    s_add_u32 s84, s86, 262144
    buffer_load_dwordx4 v5, s[60:63], s84 offen  lds
    s_add_u32 m0, s76, 46080
    s_add_u32 s84, s86, 278528
    buffer_load_dwordx4 v5, s[60:63], s84 offen  lds
    s_waitcnt vmcnt(16)
    ds_read_b64_tr_b16 v[128:129], v1 offset:0
    ds_read_b64_tr_b16 v[130:131], v1 offset:1024
    ds_read_b64_tr_b16 v[132:133], v2 offset:0
    ds_read_b64_tr_b16 v[134:135], v2 offset:1024
    ds_read_b64_tr_b16 v[136:137], v3 offset:0
    ds_read_b64_tr_b16 v[138:139], v3 offset:1024
    ds_read_b64_tr_b16 v[140:141], v4 offset:0
    ds_read_b64_tr_b16 v[142:143], v4 offset:1024
    s_waitcnt lgkmcnt(0)
    s_bfe_u32 s86, s80, 0x4000c
    s_lshl_b32 s86, s86, 19
    s_add_u32 s86, s86, s78
    s_add_u32 m0, s76, 0
    s_add_u32 s84, s86, 0
    buffer_load_dwordx4 v5, s[60:63], s84 offen  lds
    s_add_u32 m0, s76, 1024
    s_add_u32 s84, s86, 16384
    buffer_load_dwordx4 v5, s[60:63], s84 offen  lds
    s_add_u32 m0, s76, 40960
    s_add_u32 s84, s86, 262144
    buffer_load_dwordx4 v5, s[60:63], s84 offen  lds
    s_add_u32 m0, s76, 41984
    s_add_u32 s84, s86, 278528
    buffer_load_dwordx4 v5, s[60:63], s84 offen  lds
    s_waitcnt vmcnt(16)
    ds_read_b64_tr_b16 v[192:193], v1 offset:2048
    ds_read_b64_tr_b16 v[194:195], v1 offset:3072
    ds_read_b64_tr_b16 v[196:197], v2 offset:2048
    ds_read_b64_tr_b16 v[198:199], v2 offset:3072
    ds_read_b64_tr_b16 v[200:201], v3 offset:2048
    ds_read_b64_tr_b16 v[202:203], v3 offset:3072
    ds_read_b64_tr_b16 v[204:205], v4 offset:2048
    ds_read_b64_tr_b16 v[206:207], v4 offset:3072
    s_waitcnt lgkmcnt(0)
    s_bfe_u32 s86, s80, 0x40014
L_pr5:
    s_cbranch_execz L_prdone
    s_lshl_b32 s86, s86, 19
    s_add_u32 s86, s86, s78
    s_add_u32 m0, s76, 2048
    s_add_u32 s84, s86, 0
    buffer_load_dwordx4 v5, s[60:63], s84 offen  lds
    s_add_u32 m0, s76, 3072
    s_add_u32 s84, s86, 16384
    buffer_load_dwordx4 v5, s[60:63], s84 offen  lds
    s_add_u32 m0, s76, 43008
    s_add_u32 s84, s86, 262144
    buffer_load_dwordx4 v5, s[60:63], s84 offen  lds
    s_add_u32 m0, s76, 44032
    s_add_u32 s84, s86, 278528
    buffer_load_dwordx4 v5, s[60:63], s84 offen  lds
    s_waitcnt vmcnt(16)
    ds_read_b64_tr_b16 v[32:33], v1 offset:6144
    ds_read_b64_tr_b16 v[34:35], v1 offset:7168
    ds_read_b64_tr_b16 v[36:37], v2 offset:6144
    ds_read_b64_tr_b16 v[38:39], v2 offset:7168
    ds_read_b64_tr_b16 v[40:41], v3 offset:6144
    ds_read_b64_tr_b16 v[42:43], v3 offset:7168
    ds_read_b64_tr_b16 v[44:45], v4 offset:6144
    ds_read_b64_tr_b16 v[46:47], v4 offset:7168
    s_waitcnt lgkmcnt(0)
    s_bfe_u32 s86, s80, 0x40018
    s_lshl_b32 s86, s86, 19
    s_add_u32 s86, s86, s78
    s_add_u32 m0, s76, 6144
    s_add_u32 s84, s86, 0
    buffer_load_dwordx4 v5, s[60:63], s84 offen  lds
    s_add_u32 m0, s76, 7168
    s_add_u32 s84, s86, 16384
    buffer_load_dwordx4 v5, s[60:63], s84 offen  lds
    s_add_u32 m0, s76, 47104
    s_add_u32 s84, s86, 262144
    buffer_load_dwordx4 v5, s[60:63], s84 offen  lds
    s_add_u32 m0, s76, 48128
    s_add_u32 s84, s86, 278528
    buffer_load_dwordx4 v5, s[60:63], s84 offen  lds
    s_waitcnt vmcnt(16)
    ds_read_b64_tr_b16 v[144:145], v1 offset:8192
    ds_read_b64_tr_b16 v[146:147], v1 offset:9216
    ds_read_b64_tr_b16 v[148:149], v2 offset:8192
    ds_read_b64_tr_b16 v[150:151], v2 offset:9216
    ds_read_b64_tr_b16 v[152:153], v3 offset:8192
    ds_read_b64_tr_b16 v[154:155], v3 offset:9216
    ds_read_b64_tr_b16 v[156:157], v4 offset:8192
    ds_read_b64_tr_b16 v[158:159], v4 offset:9216
    s_waitcnt lgkmcnt(0)
    s_bfe_u32 s86, s80, 0x4001c
    s_lshl_b32 s86, s86, 19
    s_add_u32 s86, s86, s78
    s_add_u32 m0, s76, 8192
    s_add_u32 s84, s86, 0
    buffer_load_dwordx4 v5, s[60:63], s84 offen  lds
    s_add_u32 m0, s76, 9216
    s_add_u32 s84, s86, 16384
    buffer_load_dwordx4 v5, s[60:63], s84 offen  lds
    s_add_u32 m0, s76, 49152
    s_add_u32 s84, s86, 262144
    buffer_load_dwordx4 v5, s[60:63], s84 offen  lds
    s_add_u32 m0, s76, 50176
    s_add_u32 s84, s86, 278528
    buffer_load_dwordx4 v5, s[60:63], s84 offen  lds
    s_waitcnt vmcnt(16)
    ds_read_b64_tr_b16 v[160:161], v1 offset:4096
    ds_read_b64_tr_b16 v[162:163], v1 offset:5120
    ds_read_b64_tr_b16 v[164:165], v2 offset:4096
    ds_read_b64_tr_b16 v[166:167], v2 offset:5120
    ds_read_b64_tr_b16 v[168:169], v3 offset:4096
    ds_read_b64_tr_b16 v[170:171], v3 offset:5120
    ds_read_b64_tr_b16 v[172:173], v4 offset:4096
    ds_read_b64_tr_b16 v[174:175], v4 offset:5120
    s_waitcnt lgkmcnt(0)
    s_bfe_u32 s86, s81, 0x40010
    s_lshl_b32 s86, s86, 19
    s_add_u32 s86, s86, s78
    s_add_u32 m0, s76, 4096
    s_add_u32 s84, s86, 0
    buffer_load_dwordx4 v5, s[60:63], s84 offen  lds
    s_add_u32 m0, s76, 5120
    s_add_u32 s84, s86, 16384
    buffer_load_dwordx4 v5, s[60:63], s84 offen  lds
    s_add_u32 m0, s76, 45056
    s_add_u32 s84, s86, 262144
    buffer_load_dwordx4 v5, s[60:63], s84 offen  lds
    s_add_u32 m0, s76, 46080
    s_add_u32 s84, s86, 278528
    buffer_load_dwordx4 v5, s[60:63], s84 offen  lds
    s_waitcnt vmcnt(16)
    ds_read_b64_tr_b16 v[176:177], v1 offset:0
    ds_read_b64_tr_b16 v[178:179], v1 offset:1024
    ds_read_b64_tr_b16 v[180:181], v2 offset:0
    ds_read_b64_tr_b16 v[182:183], v2 offset:1024
    ds_read_b64_tr_b16 v[184:185], v3 offset:0
    ds_read_b64_tr_b16 v[186:187], v3 offset:1024
    ds_read_b64_tr_b16 v[188:189], v4 offset:0
    ds_read_b64_tr_b16 v[190:191], v4 offset:1024
    s_waitcnt lgkmcnt(0)
    s_bfe_u32 s86, s81, 0x40004
    s_lshl_b32 s86, s86, 19
    s_add_u32 s86, s86, s78
    s_add_u32 m0, s76, 0
    s_add_u32 s84, s86, 0
    buffer_load_dwordx4 v5, s[60:63], s84 offen  lds
    s_add_u32 m0, s76, 1024
    s_add_u32 s84, s86, 16384
    buffer_load_dwordx4 v5, s[60:63], s84 offen  lds
    s_add_u32 m0, s76, 40960
    s_add_u32 s84, s86, 262144
    buffer_load_dwordx4 v5, s[60:63], s84 offen  lds
    s_add_u32 m0, s76, 41984
    s_add_u32 s84, s86, 278528
    buffer_load_dwordx4 v5, s[60:63], s84 offen  lds
    s_waitcnt vmcnt(16)
    ds_read_b64_tr_b16 v[208:209], v1 offset:2048
    ds_read_b64_tr_b16 v[210:211], v1 offset:3072
    ds_read_b64_tr_b16 v[212:213], v2 offset:2048
    ds_read_b64_tr_b16 v[214:215], v2 offset:3072
    ds_read_b64_tr_b16 v[216:217], v3 offset:2048
    ds_read_b64_tr_b16 v[218:219], v3 offset:3072
    ds_read_b64_tr_b16 v[220:221], v4 offset:2048
    ds_read_b64_tr_b16 v[222:223], v4 offset:3072
    s_waitcnt lgkmcnt(0)
    s_bfe_u32 s86, s81, 0x40014
    s_lshl_b32 s86, s86, 19
    s_add_u32 s86, s86, s78
    s_add_u32 m0, s76, 2048
    s_add_u32 s84, s86, 0
    buffer_load_dwordx4 v5, s[60:63], s84 offen  lds
    s_add_u32 m0, s76, 3072
    s_add_u32 s84, s86, 16384
    buffer_load_dwordx4 v5, s[60:63], s84 offen  lds
    s_add_u32 m0, s76, 43008
    s_add_u32 s84, s86, 262144
    buffer_load_dwordx4 v5, s[60:63], s84 offen  lds
    s_add_u32 m0, s76, 44032
    s_add_u32 s84, s86, 278528
    buffer_load_dwordx4 v5, s[60:63], s84 offen  lds
    s_waitcnt vmcnt(16)
    ds_read_b64_tr_b16 v[224:225], v1 offset:6144
    ds_read_b64_tr_b16 v[226:227], v1 offset:7168
    ds_read_b64_tr_b16 v[228:229], v2 offset:6144
    ds_read_b64_tr_b16 v[230:231], v2 offset:7168
    ds_read_b64_tr_b16 v[232:233], v3 offset:6144
    ds_read_b64_tr_b16 v[234:235], v3 offset:7168
    ds_read_b64_tr_b16 v[236:237], v4 offset:6144
    ds_read_b64_tr_b16 v[238:239], v4 offset:7168
    s_waitcnt lgkmcnt(0)
    s_bfe_u32 s86, s81, 0x4000c
    s_lshl_b32 s86, s86, 19
    s_add_u32 s86, s86, s78
    s_add_u32 m0, s76, 6144
    s_add_u32 s84, s86, 0
    buffer_load_dwordx4 v5, s[60:63], s84 offen  lds
    s_add_u32 m0, s76, 7168
    s_add_u32 s84, s86, 16384
    buffer_load_dwordx4 v5, s[60:63], s84 offen  lds
    s_add_u32 m0, s76, 47104
    s_add_u32 s84, s86, 262144
    buffer_load_dwordx4 v5, s[60:63], s84 offen  lds
    s_add_u32 m0, s76, 48128
    s_add_u32 s84, s86, 278528
    buffer_load_dwordx4 v5, s[60:63], s84 offen  lds
    s_waitcnt vmcnt(16)
    ds_read_b64_tr_b16 v[240:241], v1 offset:8192
    ds_read_b64_tr_b16 v[242:243], v1 offset:9216
    ds_read_b64_tr_b16 v[244:245], v2 offset:8192
    ds_read_b64_tr_b16 v[246:247], v2 offset:9216
    ds_read_b64_tr_b16 v[248:249], v3 offset:8192
    ds_read_b64_tr_b16 v[250:251], v3 offset:9216
    ds_read_b64_tr_b16 v[252:253], v4 offset:8192
    ds_read_b64_tr_b16 v[254:255], v4 offset:9216
    s_waitcnt lgkmcnt(0)
    s_bfe_u32 s86, s81, 0x40008
    s_lshl_b32 s86, s86, 19
    s_add_u32 s86, s86, s78
    s_add_u32 m0, s76, 8192
    s_add_u32 s84, s86, 0
    buffer_load_dwordx4 v5, s[60:63], s84 offen  lds
    s_add_u32 m0, s76, 9216
    s_add_u32 s84, s86, 16384
    buffer_load_dwordx4 v5, s[60:63], s84 offen  lds
    s_add_u32 m0, s76, 49152
    s_add_u32 s84, s86, 262144
    buffer_load_dwordx4 v5, s[60:63], s84 offen  lds
    s_add_u32 m0, s76, 50176
    s_add_u32 s84, s86, 278528
    buffer_load_dwordx4 v5, s[60:63], s84 offen  lds
    s_waitcnt vmcnt(12)
    ds_read_b64_tr_b16 v[48:49], v1 offset:0
    ds_read_b64_tr_b16 v[50:51], v1 offset:1024
    ds_read_b64_tr_b16 v[52:53], v2 offset:0
    ds_read_b64_tr_b16 v[54:55], v2 offset:1024
    ds_read_b64_tr_b16 v[56:57], v3 offset:0
    ds_read_b64_tr_b16 v[58:59], v3 offset:1024
    ds_read_b64_tr_b16 v[60:61], v4 offset:0
    ds_read_b64_tr_b16 v[62:63], v4 offset:1024
    s_waitcnt lgkmcnt(0)
    s_bfe_u32 s86, s81, 0x40018
    s_lshl_b32 s86, s86, 19
    s_add_u32 s86, s86, s78
    s_add_u32 m0, s76, 0
    s_add_u32 s84, s86, 0
    buffer_load_dwordx4 v5, s[60:63], s84 offen  lds
    s_add_u32 m0, s76, 1024
    s_add_u32 s84, s86, 16384
    buffer_load_dwordx4 v5, s[60:63], s84 offen  lds
    s_add_u32 m0, s76, 40960
    s_add_u32 s84, s86, 262144
    buffer_load_dwordx4 v5, s[60:63], s84 offen  lds
    s_add_u32 m0, s76, 41984
    s_add_u32 s84, s86, 278528
    buffer_load_dwordx4 v5, s[60:63], s84 offen  lds
L_p3_ready:
    s_setprio 0
    s_barrier
L_p3_go:
    s_bfe_u32 s87, s80, 0x40000
    s_lshl_b32 s87, s87, 14
    s_add_u32 s87, s87, s79
    buffer_load_dwordx4 v[8:11], v6, s[64:67], s87 offen offset:0 sc1
    buffer_load_dwordx4 v[12:15], v6, s[64:67], s87 offen offset:256 sc1
    s_add_u32 s87, s87, 262144
    buffer_load_dwordx4 v[16:19], v6, s[64:67], s87 offen offset:0 sc1
    buffer_load_dwordx4 v[20:23], v6, s[64:67], s87 offen offset:256 sc1
    s_bfe_u32 s87, s80, 0x40004
    s_lshl_b32 s87, s87, 14
    s_add_u32 s87, s87, s79
    buffer_load_dwordx4 v[24:27], v6, s[64:67], s87 offen offset:0 sc1
    buffer_load_dwordx4 v[28:31], v6, s[64:67], s87 offen offset:256 sc1
    s_waitcnt vmcnt(5)
    v_mfma_f32_16x16x32_bf16 v[64:67], v[128:131], v[8:11], 0
    v_mfma_f32_16x16x32_bf16 v[68:71], v[132:135], v[8:11], 0
    v_mfma_f32_16x16x32_bf16 v[72:75], v[136:139], v[8:11], 0
    v_mfma_f32_16x16x32_bf16 v[76:79], v[140:143], v[8:11], 0
    s_add_u32 s87, s87, 262144
    buffer_load_dwordx4 v[8:11], v6, s[64:67], s87 offen offset:0 sc1
    s_waitcnt vmcnt(5)
    v_mfma_f32_16x16x32_bf16 v[80:83], v[128:131], v[12:15], 0
    v_mfma_f32_16x16x32_bf16 v[84:87], v[132:135], v[12:15], 0
    v_mfma_f32_16x16x32_bf16 v[88:91], v[136:139], v[12:15], 0
    v_mfma_f32_16x16x32_bf16 v[92:95], v[140:143], v[12:15], 0
    buffer_load_dwordx4 v[12:15], v6, s[64:67], s87 offen offset:256 sc1
    s_waitcnt vmcnt(5)
    v_mfma_f32_16x16x32_bf16 v[96:99], v[128:131], v[16:19], 0
    v_mfma_f32_16x16x32_bf16 v[100:103], v[132:135], v[16:19], 0
    v_mfma_f32_16x16x32_bf16 v[104:107], v[136:139], v[16:19], 0
    v_mfma_f32_16x16x32_bf16 v[108:111], v[140:143], v[16:19], 0
    s_bfe_u32 s87, s80, 0x40008
    s_lshl_b32 s87, s87, 14
    s_add_u32 s87, s87, s79
    buffer_load_dwordx4 v[16:19], v6, s[64:67], s87 offen offset:0 sc1
    s_waitcnt vmcnt(5)
    v_mfma_f32_16x16x32_bf16 v[112:115], v[128:131], v[20:23], 0
    v_mfma_f32_16x16x32_bf16 v[116:119], v[132:135], v[20:23], 0
    v_mfma_f32_16x16x32_bf16 v[120:123], v[136:139], v[20:23], 0
    v_mfma_f32_16x16x32_bf16 v[124:127], v[140:143], v[20:23], 0
    buffer_load_dwordx4 v[20:23], v6, s[64:67], s87 offen offset:256 sc1
    ds_read_b64_tr_b16 v[128:129], v1 offset:8192
    ds_read_b64_tr_b16 v[130:131], v1 offset:9216
    ds_read_b64_tr_b16 v[132:133], v2 offset:8192
    ds_read_b64_tr_b16 v[134:135], v2 offset:9216
    ds_read_b64_tr_b16 v[136:137], v3 offset:8192
    ds_read_b64_tr_b16 v[138:139], v3 offset:9216
    ds_read_b64_tr_b16 v[140:141], v4 offset:8192
    ds_read_b64_tr_b16 v[142:143], v4 offset:9216
    s_waitcnt vmcnt(5)
    v_mfma_f32_16x16x32_bf16 v[64:67], v[144:147], v[24:27], v[64:67]
    v_mfma_f32_16x16x32_bf16 v[68:71], v[148:151], v[24:27], v[68:71]
    v_mfma_f32_16x16x32_bf16 v[72:75], v[152:155], v[24:27], v[72:75]
    v_mfma_f32_16x16x32_bf16 v[76:79], v[156:159], v[24:27], v[76:79]
    s_add_u32 s87, s87, 262144
    buffer_load_dwordx4 v[24:27], v6, s[64:67], s87 offen offset:0 sc1
    s_waitcnt vmcnt(5)
    v_mfma_f32_16x16x32_bf16 v[80:83], v[144:147], v[28:31], v[80:83]
    v_mfma_f32_16x16x32_bf16 v[84:87], v[148:151], v[28:31], v[84:87]
    v_mfma_f32_16x16x32_bf16 v[88:91], v[152:155], v[28:31], v[88:91]
    v_mfma_f32_16x16x32_bf16 v[92:95], v[156:159], v[28:31], v[92:95]
    buffer_load_dwordx4 v[28:31], v6, s[64:67], s87 offen offset:256 sc1
    s_waitcnt lgkmcnt(0)
    s_bfe_u32 s86, s81, 0x4001c
    s_lshl_b32 s86, s86, 19
    s_add_u32 s86, s86, s78
    s_add_u32 m0, s76, 8192
    s_add_u32 s84, s86, 0
    buffer_load_dwordx4 v5, s[60:63], s84 offen  lds
    s_add_u32 m0, s76, 9216
    s_add_u32 s84, s86, 16384
    buffer_load_dwordx4 v5, s[60:63], s84 offen  lds
    s_add_u32 m0, s76, 49152
    s_add_u32 s84, s86, 262144
    buffer_load_dwordx4 v5, s[60:63], s84 offen  lds
    s_add_u32 m0, s76, 50176
    s_add_u32 s84, s86, 278528
    buffer_load_dwordx4 v5, s[60:63], s84 offen  lds
    s_waitcnt vmcnt(9)
    v_mfma_f32_16x16x32_bf16 v[96:99], v[144:147], v[8:11], v[96:99]
    v_mfma_f32_16x16x32_bf16 v[100:103], v[148:151], v[8:11], v[100:103]
    v_mfma_f32_16x16x32_bf16 v[104:107], v[152:155], v[8:11], v[104:107]
    v_mfma_f32_16x16x32_bf16 v[108:111], v[156:159], v[8:11], v[108:111]
    s_bfe_u32 s87, s80, 0x4000c
    s_lshl_b32 s87, s87, 14
    s_add_u32 s87, s87, s79
    buffer_load_dwordx4 v[8:11], v6, s[64:67], s87 offen offset:0 sc1
    s_waitcnt vmcnt(9)
    v_mfma_f32_16x16x32_bf16 v[112:115], v[144:147], v[12:15], v[112:115]
    v_mfma_f32_16x16x32_bf16 v[116:119], v[148:151], v[12:15], v[116:119]
    v_mfma_f32_16x16x32_bf16 v[120:123], v[152:155], v[12:15], v[120:123]
    v_mfma_f32_16x16x32_bf16 v[124:127], v[156:159], v[12:15], v[124:127]
    buffer_load_dwordx4 v[12:15], v6, s[64:67], s87 offen offset:256 sc1
    ds_read_b64_tr_b16 v[144:145], v1 offset:6144
    ds_read_b64_tr_b16 v[146:147], v1 offset:7168
    ds_read_b64_tr_b16 v[148:149], v2 offset:6144
    ds_read_b64_tr_b16 v[150:151], v2 offset:7168
    ds_read_b64_tr_b16 v[152:153], v3 offset:6144
    ds_read_b64_tr_b16 v[154:155], v3 offset:7168
    ds_read_b64_tr_b16 v[156:157], v4 offset:6144
    ds_read_b64_tr_b16 v[158:159], v4 offset:7168
    s_waitcnt vmcnt(9)
    v_mfma_f32_16x16x32_bf16 v[64:67], v[160:163], v[16:19], v[64:67]
    v_mfma_f32_16x16x32_bf16 v[68:71], v[164:167], v[16:19], v[68:71]
    v_mfma_f32_16x16x32_bf16 v[72:75], v[168:171], v[16:19], v[72:75]
    v_mfma_f32_16x16x32_bf16 v[76:79], v[172:175], v[16:19], v[76:79]
    s_add_u32 s87, s87, 262144
    buffer_load_dwordx4 v[16:19], v6, s[64:67], s87 offen offset:0 sc1
    s_waitcnt vmcnt(9)
    v_mfma_f32_16x16x32_bf16 v[80:83], v[160:163], v[20:23], v[80:83]
    v_mfma_f32_16x16x32_bf16 v[84:87], v[164:167], v[20:23], v[84:87]
    v_mfma_f32_16x16x32_bf16 v[88:91], v[168:171], v[20:23], v[88:91]
    v_mfma_f32_16x16x32_bf16 v[92:95], v[172:175], v[20:23], v[92:95]
    buffer_load_dwordx4 v[20:23], v6, s[64:67], s87 offen offset:256 sc1
    s_waitcnt vmcnt(9)
    v_mfma_f32_16x16x32_bf16 v[96:99], v[160:163], v[24:27], v[96:99]
    v_mfma_f32_16x16x32_bf16 v[100:103], v[164:167], v[24:27], v[100:103]
    v_mfma_f32_16x16x32_bf16 v[104:107], v[168:171], v[24:27], v[104:107]
    v_mfma_f32_16x16x32_bf16 v[108:111], v[172:175], v[24:27], v[108:111]
    s_bfe_u32 s87, s80, 0x40010
    s_lshl_b32 s87, s87, 14
    s_add_u32 s87, s87, s79
    buffer_load_dwordx4 v[24:27], v6, s[64:67], s87 offen offset:0 sc1
    s_waitcnt vmcnt(9)
    v_mfma_f32_16x16x32_bf16 v[112:115], v[160:163], v[28:31], v[112:115]
    v_mfma_f32_16x16x32_bf16 v[116:119], v[164:167], v[28:31], v[116:119]
    v_mfma_f32_16x16x32_bf16 v[120:123], v[168:171], v[28:31], v[120:123]
    v_mfma_f32_16x16x32_bf16 v[124:127], v[172:175], v[28:31], v[124:127]
    buffer_load_dwordx4 v[28:31], v6, s[64:67], s87 offen offset:256 sc1
    ds_read_b64_tr_b16 v[160:161], v1 offset:4096
    ds_read_b64_tr_b16 v[162:163], v1 offset:5120
    ds_read_b64_tr_b16 v[164:165], v2 offset:4096
    ds_read_b64_tr_b16 v[166:167], v2 offset:5120
    ds_read_b64_tr_b16 v[168:169], v3 offset:4096
    ds_read_b64_tr_b16 v[170:171], v3 offset:5120
    ds_read_b64_tr_b16 v[172:173], v4 offset:4096
    ds_read_b64_tr_b16 v[174:175], v4 offset:5120
    s_waitcnt vmcnt(5)
    v_mfma_f32_16x16x32_bf16 v[64:67], v[176:179], v[8:11], v[64:67]
    v_mfma_f32_16x16x32_bf16 v[68:71], v[180:183], v[8:11], v[68:71]
    v_mfma_f32_16x16x32_bf16 v[72:75], v[184:187], v[8:11], v[72:75]
    v_mfma_f32_16x16x32_bf16 v[76:79], v[188:191], v[8:11], v[76:79]
    s_add_u32 s87, s87, 262144
    buffer_load_dwordx4 v[8:11], v6, s[64:67], s87 offen offset:0 sc1
    s_waitcnt vmcnt(5)
    v_mfma_f32_16x16x32_bf16 v[80:83], v[176:179], v[12:15], v[80:83]
    v_mfma_f32_16x16x32_bf16 v[84:87], v[180:183], v[12:15], v[84:87]
    v_mfma_f32_16x16x32_bf16 v[88:91], v[184:187], v[12:15], v[88:91]
    v_mfma_f32_16x16x32_bf16 v[92:95], v[188:191], v[12:15], v[92:95]
    buffer_load_dwordx4 v[12:15], v6, s[64:67], s87 offen offset:256 sc1
    s_waitcnt vmcnt(5)
    v_mfma_f32_16x16x32_bf16 v[96:99], v[176:179], v[16:19], v[96:99]
    v_mfma_f32_16x16x32_bf16 v[100:103], v[180:183], v[16:19], v[100:103]
    v_mfma_f32_16x16x32_bf16 v[104:107], v[184:187], v[16:19], v[104:107]
    v_mfma_f32_16x16x32_bf16 v[108:111], v[188:191], v[16:19], v[108:111]
    s_bfe_u32 s87, s80, 0x40014
    s_lshl_b32 s87, s87, 14
    s_add_u32 s87, s87, s79
    buffer_load_dwordx4 v[16:19], v6, s[64:67], s87 offen offset:0 sc1
    s_waitcnt vmcnt(5)
    v_mfma_f32_16x16x32_bf16 v[112:115], v[176:179], v[20:23], v[112:115]
    v_mfma_f32_16x16x32_bf16 v[116:119], v[180:183], v[20:23], v[116:119]
    v_mfma_f32_16x16x32_bf16 v[120:123], v[184:187], v[20:23], v[120:123]
    v_mfma_f32_16x16x32_bf16 v[124:127], v[188:191], v[20:23], v[124:127]
    buffer_load_dwordx4 v[20:23], v6, s[64:67], s87 offen offset:256 sc1
    ds_read_b64_tr_b16 v[176:177], v1 offset:2048
    ds_read_b64_tr_b16 v[178:179], v1 offset:3072
    ds_read_b64_tr_b16 v[180:181], v2 offset:2048
    ds_read_b64_tr_b16 v[182:183], v2 offset:3072
    ds_read_b64_tr_b16 v[184:185], v3 offset:2048
    ds_read_b64_tr_b16 v[186:187], v3 offset:3072
    ds_read_b64_tr_b16 v[188:189], v4 offset:2048
    ds_read_b64_tr_b16 v[190:191], v4 offset:3072
    s_waitcnt vmcnt(5)
    v_mfma_f32_16x16x32_bf16 v[64:67], v[192:195], v[24:27], v[64:67]
    v_mfma_f32_16x16x32_bf16 v[68:71], v[196:199], v[24:27], v[68:71]
    v_mfma_f32_16x16x32_bf16 v[72:75], v[200:203], v[24:27], v[72:75]
    v_mfma_f32_16x16x32_bf16 v[76:79], v[204:207], v[24:27], v[76:79]
    s_add_u32 s87, s87, 262144
    buffer_load_dwordx4 v[24:27], v6, s[64:67], s87 offen offset:0 sc1
    s_waitcnt vmcnt(5)
    v_mfma_f32_16x16x32_bf16 v[80:83], v[192:195], v[28:31], v[80:83]
    v_mfma_f32_16x16x32_bf16 v[84:87], v[196:199], v[28:31], v[84:87]
    v_mfma_f32_16x16x32_bf16 v[88:91], v[200:203], v[28:31], v[88:91]
    v_mfma_f32_16x16x32_bf16 v[92:95], v[204:207], v[28:31], v[92:95]
    buffer_load_dwordx4 v[28:31], v6, s[64:67], s87 offen offset:256 sc1
    s_waitcnt vmcnt(5)
    v_mfma_f32_16x16x32_bf16 v[96:99], v[192:195], v[8:11], v[96:99]
    v_mfma_f32_16x16x32_bf16 v[100:103], v[196:199], v[8:11], v[100:103]
    v_mfma_f32_16x16x32_bf16 v[104:107], v[200:203], v[8:11], v[104:107]
    v_mfma_f32_16x16x32_bf16 v[108:111], v[204:207], v[8:11], v[108:111]
    s_bfe_u32 s87, s80, 0x40018
    s_lshl_b32 s87, s87, 14
    s_add_u32 s87, s87, s79
    buffer_load_dwordx4 v[8:11], v6, s[64:67], s87 offen offset:0 sc1
    s_waitcnt vmcnt(5)
    v_mfma_f32_16x16x32_bf16 v[112:115], v[192:195], v[12:15], v[112:115]
    v_mfma_f32_16x16x32_bf16 v[116:119], v[196:199], v[12:15], v[116:119]
    v_mfma_f32_16x16x32_bf16 v[120:123], v[200:203], v[12:15], v[120:123]
    v_mfma_f32_16x16x32_bf16 v[124:127], v[204:207], v[12:15], v[124:127]
    buffer_load_dwordx4 v[12:15], v6, s[64:67], s87 offen offset:256 sc1
    ds_read_b64_tr_b16 v[192:193], v1 offset:0
    ds_read_b64_tr_b16 v[194:195], v1 offset:1024
    ds_read_b64_tr_b16 v[196:197], v2 offset:0
    ds_read_b64_tr_b16 v[198:199], v2 offset:1024
    ds_read_b64_tr_b16 v[200:201], v3 offset:0
    ds_read_b64_tr_b16 v[202:203], v3 offset:1024
    ds_read_b64_tr_b16 v[204:205], v4 offset:0
    ds_read_b64_tr_b16 v[206:207], v4 offset:1024
    s_waitcnt vmcnt(5)
    v_mfma_f32_16x16x32_bf16 v[64:67], v[208:211], v[16:19], v[64:67]
    v_mfma_f32_16x16x32_bf16 v[68:71], v[212:215], v[16:19], v[68:71]
    v_mfma_f32_16x16x32_bf16 v[72:75], v[216:219], v[16:19], v[72:75]
    v_mfma_f32_16x16x32_bf16 v[76:79], v[220:223], v[16:19], v[76:79]
    s_add_u32 s87, s87, 262144
    buffer_load_dwordx4 v[16:19], v6, s[64:67], s87 offen offset:0 sc1
    s_waitcnt vmcnt(5)
    v_mfma_f32_16x16x32_bf16 v[80:83], v[208:211], v[20:23], v[80:83]
    v_mfma_f32_16x16x32_bf16 v[84:87], v[212:215], v[20:23], v[84:87]
    v_mfma_f32_16x16x32_bf16 v[88:91], v[216:219], v[20:23], v[88:91]
    v_mfma_f32_16x16x32_bf16 v[92:95], v[220:223], v[20:23], v[92:95]
    buffer_load_dwordx4 v[20:23], v6, s[64:67], s87 offen offset:256 sc1
    s_waitcnt vmcnt(5)
    v_mfma_f32_16x16x32_bf16 v[96:99], v[208:211], v[24:27], v[96:99]
    v_mfma_f32_16x16x32_bf16 v[100:103], v[212:215], v[24:27], v[100:103]
    v_mfma_f32_16x16x32_bf16 v[104:107], v[216:219], v[24:27], v[104:107]
    v_mfma_f32_16x16x32_bf16 v[108:111], v[220:223], v[24:27], v[108:111]
    s_bfe_u32 s87, s80, 0x4001c
    s_lshl_b32 s87, s87, 14
    s_add_u32 s87, s87, s79
    buffer_load_dwordx4 v[24:27], v6, s[64:67], s87 offen offset:0 sc1
    s_waitcnt vmcnt(5)
    v_mfma_f32_16x16x32_bf16 v[112:115], v[208:211], v[28:31], v[112:115]
    v_mfma_f32_16x16x32_bf16 v[116:119], v[212:215], v[28:31], v[116:119]
    v_mfma_f32_16x16x32_bf16 v[120:123], v[216:219], v[28:31], v[120:123]
    v_mfma_f32_16x16x32_bf16 v[124:127], v[220:223], v[28:31], v[124:127]
    buffer_load_dwordx4 v[28:31], v6, s[64:67], s87 offen offset:256 sc1
    ds_read_b64_tr_b16 v[208:209], v1 offset:8192
    ds_read_b64_tr_b16 v[210:211], v1 offset:9216
    ds_read_b64_tr_b16 v[212:213], v2 offset:8192
    ds_read_b64_tr_b16 v[214:215], v2 offset:9216
    ds_read_b64_tr_b16 v[216:217], v3 offset:8192
    ds_read_b64_tr_b16 v[218:219], v3 offset:9216
    ds_read_b64_tr_b16 v[220:221], v4 offset:8192
    ds_read_b64_tr_b16 v[222:223], v4 offset:9216
    s_waitcnt vmcnt(5)
    v_mfma_f32_16x16x32_bf16 v[64:67], v[224:227], v[8:11], v[64:67]
    v_mfma_f32_16x16x32_bf16 v[68:71], v[228:231], v[8:11], v[68:71]
    v_mfma_f32_16x16x32_bf16 v[72:75], v[232:235], v[8:11], v[72:75]
    v_mfma_f32_16x16x32_bf16 v[76:79], v[236:239], v[8:11], v[76:79]
    s_add_u32 s87, s87, 262144
    buffer_load_dwordx4 v[8:11], v6, s[64:67], s87 offen offset:0 sc1
    s_waitcnt vmcnt(5)
    v_mfma_f32_16x16x32_bf16 v[80:83], v[224:227], v[12:15], v[80:83]
    v_mfma_f32_16x16x32_bf16 v[84:87], v[228:231], v[12:15], v[84:87]
    v_mfma_f32_16x16x32_bf16 v[88:91], v[232:235], v[12:15], v[88:91]
    v_mfma_f32_16x16x32_bf16 v[92:95], v[236:239], v[12:15], v[92:95]
    buffer_load_dwordx4 v[12:15], v6, s[64:67], s87 offen offset:256 sc1
    s_waitcnt vmcnt(5)
    v_mfma_f32_16x16x32_bf16 v[96:99], v[224:227], v[16:19], v[96:99]
    v_mfma_f32_16x16x32_bf16 v[100:103], v[228:231], v[16:19], v[100:103]
    v_mfma_f32_16x16x32_bf16 v[104:107], v[232:235], v[16:19], v[104:107]
    v_mfma_f32_16x16x32_bf16 v[108:111], v[236:239], v[16:19], v[108:111]
    s_bfe_u32 s87, s81, 0x40000
    s_lshl_b32 s87, s87, 14
    s_add_u32 s87, s87, s79
    buffer_load_dwordx4 v[16:19], v6, s[64:67], s87 offen offset:0 sc1
    s_waitcnt vmcnt(5)
    v_mfma_f32_16x16x32_bf16 v[112:115], v[224:227], v[20:23], v[112:115]
    v_mfma_f32_16x16x32_bf16 v[116:119], v[228:231], v[20:23], v[116:119]
    v_mfma_f32_16x16x32_bf16 v[120:123], v[232:235], v[20:23], v[120:123]
    v_mfma_f32_16x16x32_bf16 v[124:127], v[236:239], v[20:23], v[124:127]
    buffer_load_dwordx4 v[20:23], v6, s[64:67], s87 offen offset:256 sc1
    s_waitcnt vmcnt(5)
    v_mfma_f32_16x16x32_bf16 v[64:67], v[240:243], v[24:27], v[64:67]
    v_mfma_f32_16x16x32_bf16 v[68:71], v[244:247], v[24:27], v[68:71]
    v_mfma_f32_16x16x32_bf16 v[72:75], v[248:251], v[24:27], v[72:75]
    v_mfma_f32_16x16x32_bf16 v[76:79], v[252:255], v[24:27], v[76:79]
    s_add_u32 s87, s87, 262144
    buffer_load_dwordx4 v[24:27], v6, s[64:67], s87 offen offset:0 sc1
    s_waitcnt vmcnt(5)
    v_mfma_f32_16x16x32_bf16 v[80:83], v[240:243], v[28:31], v[80:83]
    v_mfma_f32_16x16x32_bf16 v[84:87], v[244:247], v[28:31], v[84:87]
    v_mfma_f32_16x16x32_bf16 v[88:91], v[248:251], v[28:31], v[88:91]
    v_mfma_f32_16x16x32_bf16 v[92:95], v[252:255], v[28:31], v[92:95]
    buffer_load_dwordx4 v[28:31], v6, s[64:67], s87 offen offset:256 sc1
    s_waitcnt vmcnt(5)
    v_mfma_f32_16x16x32_bf16 v[96:99], v[240:243], v[8:11], v[96:99]
    v_mfma_f32_16x16x32_bf16 v[100:103], v[244:247], v[8:11], v[100:103]
    v_mfma_f32_16x16x32_bf16 v[104:107], v[248:251], v[8:11], v[104:107]
    v_mfma_f32_16x16x32_bf16 v[108:111], v[252:255], v[8:11], v[108:111]
    s_bfe_u32 s87, s81, 0x40004
    s_lshl_b32 s87, s87, 14
    s_add_u32 s87, s87, s79
    buffer_load_dwordx4 v[8:11], v6, s[64:67], s87 offen offset:0 sc1
    s_waitcnt vmcnt(5)
    v_mfma_f32_16x16x32_bf16 v[112:115], v[240:243], v[12:15], v[112:115]
    v_mfma_f32_16x16x32_bf16 v[116:119], v[244:247], v[12:15], v[116:119]
    v_mfma_f32_16x16x32_bf16 v[120:123], v[248:251], v[12:15], v[120:123]
    v_mfma_f32_16x16x32_bf16 v[124:127], v[252:255], v[12:15], v[124:127]
    buffer_load_dwordx4 v[12:15], v6, s[64:67], s87 offen offset:256 sc1
    s_waitcnt vmcnt(5)
    v_mfma_f32_16x16x32_bf16 v[64:67], v[32:35], v[16:19], v[64:67]
    v_mfma_f32_16x16x32_bf16 v[68:71], v[36:39], v[16:19], v[68:71]
    v_mfma_f32_16x16x32_bf16 v[72:75], v[40:43], v[16:19], v[72:75]
    v_mfma_f32_16x16x32_bf16 v[76:79], v[44:47], v[16:19], v[76:79]
    s_add_u32 s87, s87, 262144
    buffer_load_dwordx4 v[16:19], v6, s[64:67], s87 offen offset:0 sc1
    s_waitcnt vmcnt(5)
    v_mfma_f32_16x16x32_bf16 v[80:83], v[32:35], v[20:23], v[80:83]
    v_mfma_f32_16x16x32_bf16 v[84:87], v[36:39], v[20:23], v[84:87]
    v_mfma_f32_16x16x32_bf16 v[88:91], v[40:43], v[20:23], v[88:91]
    v_mfma_f32_16x16x32_bf16 v[92:95], v[44:47], v[20:23], v[92:95]
    buffer_load_dwordx4 v[20:23], v6, s[64:67], s87 offen offset:256 sc1
    s_waitcnt vmcnt(5)
    v_mfma_f32_16x16x32_bf16 v[96:99], v[32:35], v[24:27], v[96:99]
    v_mfma_f32_16x16x32_bf16 v[100:103], v[36:39], v[24:27], v[100:103]
    v_mfma_f32_16x16x32_bf16 v[104:107], v[40:43], v[24:27], v[104:107]
    v_mfma_f32_16x16x32_bf16 v[108:111], v[44:47], v[24:27], v[108:111]
    s_bfe_u32 s87, s81, 0x40008
    s_lshl_b32 s87, s87, 14
    s_add_u32 s87, s87, s79
    buffer_load_dwordx4 v[24:27], v6, s[64:67], s87 offen offset:0 sc1
    s_waitcnt vmcnt(5)
    v_mfma_f32_16x16x32_bf16 v[112:115], v[32:35], v[28:31], v[112:115]
    v_mfma_f32_16x16x32_bf16 v[116:119], v[36:39], v[28:31], v[116:119]
    v_mfma_f32_16x16x32_bf16 v[120:123], v[40:43], v[28:31], v[120:123]
    v_mfma_f32_16x16x32_bf16 v[124:127], v[44:47], v[28:31], v[124:127]
    buffer_load_dwordx4 v[28:31], v6, s[64:67], s87 offen offset:256 sc1
    s_waitcnt vmcnt(5)
    v_mfma_f32_16x16x32_bf16 v[64:67], v[48:51], v[8:11], v[64:67]
    v_mfma_f32_16x16x32_bf16 v[68:71], v[52:55], v[8:11], v[68:71]
    v_mfma_f32_16x16x32_bf16 v[72:75], v[56:59], v[8:11], v[72:75]
    v_mfma_f32_16x16x32_bf16 v[76:79], v[60:63], v[8:11], v[76:79]
    s_add_u32 s87, s87, 262144
    buffer_load_dwordx4 v[8:11], v6, s[64:67], s87 offen offset:0 sc1
    s_waitcnt vmcnt(5)
    v_mfma_f32_16x16x32_bf16 v[80:83], v[48:51], v[12:15], v[80:83]
    v_mfma_f32_16x16x32_bf16 v[84:87], v[52:55], v[12:15], v[84:87]
    v_mfma_f32_16x16x32_bf16 v[88:91], v[56:59], v[12:15], v[88:91]
    v_mfma_f32_16x16x32_bf16 v[92:95], v[60:63], v[12:15], v[92:95]
    buffer_load_dwordx4 v[12:15], v6, s[64:67], s87 offen offset:256 sc1
    s_waitcnt vmcnt(5)
    v_mfma_f32_16x16x32_bf16 v[96:99], v[48:51], v[16:19], v[96:99]
    v_mfma_f32_16x16x32_bf16 v[100:103], v[52:55], v[16:19], v[100:103]
    v_mfma_f32_16x16x32_bf16 v[104:107], v[56:59], v[16:19], v[104:107]
    v_mfma_f32_16x16x32_bf16 v[108:111], v[60:63], v[16:19], v[108:111]
    s_bfe_u32 s87, s81, 0x4000c
    s_lshl_b32 s87, s87, 14
    s_add_u32 s87, s87, s79
    buffer_load_dwordx4 v[16:19], v6, s[64:67], s87 offen offset:0 sc1
    s_waitcnt vmcnt(5)
    v_mfma_f32_16x16x32_bf16 v[112:115], v[48:51], v[20:23], v[112:115]
L_pr6:
    s_cbranch_execz L_prdone
    v_mfma_f32_16x16x32_bf16 v[116:119], v[52:55], v[20:23], v[116:119]
    v_mfma_f32_16x16x32_bf16 v[120:123], v[56:59], v[20:23], v[120:123]
    v_mfma_f32_16x16x32_bf16 v[124:127], v[60:63], v[20:23], v[124:127]
    buffer_load_dwordx4 v[20:23], v6, s[64:67], s87 offen offset:256 sc1
    s_waitcnt lgkmcnt(0)
    s_waitcnt vmcnt(5)
    v_mfma_f32_16x16x32_bf16 v[64:67], v[128:131], v[24:27], v[64:67]
    v_mfma_f32_16x16x32_bf16 v[68:71], v[132:135], v[24:27], v[68:71]
    v_mfma_f32_16x16x32_bf16 v[72:75], v[136:139], v[24:27], v[72:75]
    v_mfma_f32_16x16x32_bf16 v[76:79], v[140:143], v[24:27], v[76:79]
    s_add_u32 s87, s87, 262144
    buffer_load_dwordx4 v[24:27], v6, s[64:67], s87 offen offset:0 sc1
    s_waitcnt vmcnt(5)
    v_mfma_f32_16x16x32_bf16 v[80:83], v[128:131], v[28:31], v[80:83]
    v_mfma_f32_16x16x32_bf16 v[84:87], v[132:135], v[28:31], v[84:87]
    v_mfma_f32_16x16x32_bf16 v[88:91], v[136:139], v[28:31], v[88:91]
    v_mfma_f32_16x16x32_bf16 v[92:95], v[140:143], v[28:31], v[92:95]
    buffer_load_dwordx4 v[28:31], v6, s[64:67], s87 offen offset:256 sc1
    s_waitcnt vmcnt(5)
    v_mfma_f32_16x16x32_bf16 v[96:99], v[128:131], v[8:11], v[96:99]
    v_mfma_f32_16x16x32_bf16 v[100:103], v[132:135], v[8:11], v[100:103]
    v_mfma_f32_16x16x32_bf16 v[104:107], v[136:139], v[8:11], v[104:107]
    v_mfma_f32_16x16x32_bf16 v[108:111], v[140:143], v[8:11], v[108:111]
    s_bfe_u32 s87, s81, 0x40010
    s_lshl_b32 s87, s87, 14
    s_add_u32 s87, s87, s79
    buffer_load_dwordx4 v[8:11], v6, s[64:67], s87 offen offset:0 sc1
    s_waitcnt vmcnt(5)
    v_mfma_f32_16x16x32_bf16 v[112:115], v[128:131], v[12:15], v[112:115]
    v_mfma_f32_16x16x32_bf16 v[116:119], v[132:135], v[12:15], v[116:119]
    v_mfma_f32_16x16x32_bf16 v[120:123], v[136:139], v[12:15], v[120:123]
    v_mfma_f32_16x16x32_bf16 v[124:127], v[140:143], v[12:15], v[124:127]
    buffer_load_dwordx4 v[12:15], v6, s[64:67], s87 offen offset:256 sc1
    s_waitcnt lgkmcnt(0)
    s_waitcnt vmcnt(5)
    v_mfma_f32_16x16x32_bf16 v[64:67], v[144:147], v[16:19], v[64:67]
    v_mfma_f32_16x16x32_bf16 v[68:71], v[148:151], v[16:19], v[68:71]
    v_mfma_f32_16x16x32_bf16 v[72:75], v[152:155], v[16:19], v[72:75]
    v_mfma_f32_16x16x32_bf16 v[76:79], v[156:159], v[16:19], v[76:79]
    s_add_u32 s87, s87, 262144
    buffer_load_dwordx4 v[16:19], v6, s[64:67], s87 offen offset:0 sc1
    s_waitcnt vmcnt(5)
    v_mfma_f32_16x16x32_bf16 v[80:83], v[144:147], v[20:23], v[80:83]
    v_mfma_f32_16x16x32_bf16 v[84:87], v[148:151], v[20:23], v[84:87]
    v_mfma_f32_16x16x32_bf16 v[88:91], v[152:155], v[20:23], v[88:91]
    v_mfma_f32_16x16x32_bf16 v[92:95], v[156:159], v[20:23], v[92:95]
    buffer_load_dwordx4 v[20:23], v6, s[64:67], s87 offen offset:256 sc1
    s_waitcnt vmcnt(5)
    v_mfma_f32_16x16x32_bf16 v[96:99], v[144:147], v[24:27], v[96:99]
    v_mfma_f32_16x16x32_bf16 v[100:103], v[148:151], v[24:27], v[100:103]
    v_mfma_f32_16x16x32_bf16 v[104:107], v[152:155], v[24:27], v[104:107]
    v_mfma_f32_16x16x32_bf16 v[108:111], v[156:159], v[24:27], v[108:111]
    s_bfe_u32 s87, s81, 0x40014
    s_lshl_b32 s87, s87, 14
    s_add_u32 s87, s87, s79
    buffer_load_dwordx4 v[24:27], v6, s[64:67], s87 offen offset:0 sc1
    s_waitcnt vmcnt(5)
    v_mfma_f32_16x16x32_bf16 v[112:115], v[144:147], v[28:31], v[112:115]
    v_mfma_f32_16x16x32_bf16 v[116:119], v[148:151], v[28:31], v[116:119]
    v_mfma_f32_16x16x32_bf16 v[120:123], v[152:155], v[28:31], v[120:123]
    v_mfma_f32_16x16x32_bf16 v[124:127], v[156:159], v[28:31], v[124:127]
    buffer_load_dwordx4 v[28:31], v6, s[64:67], s87 offen offset:256 sc1
    s_waitcnt lgkmcnt(0)
    s_waitcnt vmcnt(5)
    v_mfma_f32_16x16x32_bf16 v[64:67], v[160:163], v[8:11], v[64:67]
    v_mfma_f32_16x16x32_bf16 v[68:71], v[164:167], v[8:11], v[68:71]
    v_mfma_f32_16x16x32_bf16 v[72:75], v[168:171], v[8:11], v[72:75]
    v_mfma_f32_16x16x32_bf16 v[76:79], v[172:175], v[8:11], v[76:79]
    s_add_u32 s87, s87, 262144
    buffer_load_dwordx4 v[8:11], v6, s[64:67], s87 offen offset:0 sc1
    s_waitcnt vmcnt(5)
    v_mfma_f32_16x16x32_bf16 v[80:83], v[160:163], v[12:15], v[80:83]
    v_mfma_f32_16x16x32_bf16 v[84:87], v[164:167], v[12:15], v[84:87]
    v_mfma_f32_16x16x32_bf16 v[88:91], v[168:171], v[12:15], v[88:91]
    v_mfma_f32_16x16x32_bf16 v[92:95], v[172:175], v[12:15], v[92:95]
    buffer_load_dwordx4 v[12:15], v6, s[64:67], s87 offen offset:256 sc1
    s_waitcnt vmcnt(5)
    v_mfma_f32_16x16x32_bf16 v[96:99], v[160:163], v[16:19], v[96:99]
    v_mfma_f32_16x16x32_bf16 v[100:103], v[164:167], v[16:19], v[100:103]
    v_mfma_f32_16x16x32_bf16 v[104:107], v[168:171], v[16:19], v[104:107]
    v_mfma_f32_16x16x32_bf16 v[108:111], v[172:175], v[16:19], v[108:111]
    s_bfe_u32 s87, s81, 0x40018
    s_lshl_b32 s87, s87, 14
    s_add_u32 s87, s87, s79
    buffer_load_dwordx4 v[16:19], v6, s[64:67], s87 offen offset:0 sc1
    s_waitcnt vmcnt(5)
    v_mfma_f32_16x16x32_bf16 v[112:115], v[160:163], v[20:23], v[112:115]
    v_mfma_f32_16x16x32_bf16 v[116:119], v[164:167], v[20:23], v[116:119]
    v_mfma_f32_16x16x32_bf16 v[120:123], v[168:171], v[20:23], v[120:123]
    v_mfma_f32_16x16x32_bf16 v[124:127], v[172:175], v[20:23], v[124:127]
    buffer_load_dwordx4 v[20:23], v6, s[64:67], s87 offen offset:256 sc1
    s_waitcnt lgkmcnt(0)
    s_waitcnt vmcnt(5)
    v_mfma_f32_16x16x32_bf16 v[64:67], v[176:179], v[24:27], v[64:67]
    v_mfma_f32_16x16x32_bf16 v[68:71], v[180:183], v[24:27], v[68:71]
    v_mfma_f32_16x16x32_bf16 v[72:75], v[184:187], v[24:27], v[72:75]
    v_mfma_f32_16x16x32_bf16 v[76:79], v[188:191], v[24:27], v[76:79]
    s_add_u32 s87, s87, 262144
    buffer_load_dwordx4 v[24:27], v6, s[64:67], s87 offen offset:0 sc1
    s_waitcnt vmcnt(5)
    v_mfma_f32_16x16x32_bf16 v[80:83], v[176:179], v[28:31], v[80:83]
    v_mfma_f32_16x16x32_bf16 v[84:87], v[180:183], v[28:31], v[84:87]
    v_mfma_f32_16x16x32_bf16 v[88:91], v[184:187], v[28:31], v[88:91]
    v_mfma_f32_16x16x32_bf16 v[92:95], v[188:191], v[28:31], v[92:95]
    buffer_load_dwordx4 v[28:31], v6, s[64:67], s87 offen offset:256 sc1
    s_waitcnt vmcnt(5)
    v_mfma_f32_16x16x32_bf16 v[96:99], v[176:179], v[8:11], v[96:99]
    v_mfma_f32_16x16x32_bf16 v[100:103], v[180:183], v[8:11], v[100:103]
    v_mfma_f32_16x16x32_bf16 v[104:107], v[184:187], v[8:11], v[104:107]
    v_mfma_f32_16x16x32_bf16 v[108:111], v[188:191], v[8:11], v[108:111]
    s_bfe_u32 s87, s81, 0x4001c
    s_lshl_b32 s87, s87, 14
    s_add_u32 s87, s87, s79
    buffer_load_dwordx4 v[8:11], v6, s[64:67], s87 offen offset:0 sc1
    s_waitcnt vmcnt(5)
    v_mfma_f32_16x16x32_bf16 v[112:115], v[176:179], v[12:15], v[112:115]
    v_mfma_f32_16x16x32_bf16 v[116:119], v[180:183], v[12:15], v[116:119]
    v_mfma_f32_16x16x32_bf16 v[120:123], v[184:187], v[12:15], v[120:123]
    v_mfma_f32_16x16x32_bf16 v[124:127], v[188:191], v[12:15], v[124:127]
    buffer_load_dwordx4 v[12:15], v6, s[64:67], s87 offen offset:256 sc1
    s_waitcnt lgkmcnt(0)
    s_waitcnt vmcnt(5)
    v_mfma_f32_16x16x32_bf16 v[64:67], v[192:195], v[16:19], v[64:67]
    v_mfma_f32_16x16x32_bf16 v[68:71], v[196:199], v[16:19], v[68:71]
    v_mfma_f32_16x16x32_bf16 v[72:75], v[200:203], v[16:19], v[72:75]
    v_mfma_f32_16x16x32_bf16 v[76:79], v[204:207], v[16:19], v[76:79]
    s_add_u32 s87, s87, 262144
    buffer_load_dwordx4 v[16:19], v6, s[64:67], s87 offen offset:0 sc1
    s_waitcnt vmcnt(5)
    v_mfma_f32_16x16x32_bf16 v[80:83], v[192:195], v[20:23], v[80:83]
    v_mfma_f32_16x16x32_bf16 v[84:87], v[196:199], v[20:23], v[84:87]
    v_mfma_f32_16x16x32_bf16 v[88:91], v[200:203], v[20:23], v[88:91]
    v_mfma_f32_16x16x32_bf16 v[92:95], v[204:207], v[20:23], v[92:95]
    buffer_load_dwordx4 v[20:23], v6, s[64:67], s87 offen offset:256 sc1
    s_waitcnt vmcnt(5)
    v_mfma_f32_16x16x32_bf16 v[96:99], v[192:195], v[24:27], v[96:99]
    v_mfma_f32_16x16x32_bf16 v[100:103], v[196:199], v[24:27], v[100:103]
    v_mfma_f32_16x16x32_bf16 v[104:107], v[200:203], v[24:27], v[104:107]
    v_mfma_f32_16x16x32_bf16 v[108:111], v[204:207], v[24:27], v[108:111]
    s_waitcnt vmcnt(4)
    v_mfma_f32_16x16x32_bf16 v[112:115], v[192:195], v[28:31], v[112:115]
    v_mfma_f32_16x16x32_bf16 v[116:119], v[196:199], v[28:31], v[116:119]
    v_mfma_f32_16x16x32_bf16 v[120:123], v[200:203], v[28:31], v[120:123]
    v_mfma_f32_16x16x32_bf16 v[124:127], v[204:207], v[28:31], v[124:127]
    s_waitcnt lgkmcnt(0)
    s_waitcnt vmcnt(3)
    v_mfma_f32_16x16x32_bf16 v[64:67], v[208:211], v[8:11], v[64:67]
    v_mfma_f32_16x16x32_bf16 v[68:71], v[212:215], v[8:11], v[68:71]
    v_mfma_f32_16x16x32_bf16 v[72:75], v[216:219], v[8:11], v[72:75]
    v_mfma_f32_16x16x32_bf16 v[76:79], v[220:223], v[8:11], v[76:79]
    s_waitcnt vmcnt(2)
    v_mfma_f32_16x16x32_bf16 v[80:83], v[208:211], v[12:15], v[80:83]
    v_mfma_f32_16x16x32_bf16 v[84:87], v[212:215], v[12:15], v[84:87]
    v_mfma_f32_16x16x32_bf16 v[88:91], v[216:219], v[12:15], v[88:91]
    v_mfma_f32_16x16x32_bf16 v[92:95], v[220:223], v[12:15], v[92:95]
    s_waitcnt vmcnt(1)
    v_mfma_f32_16x16x32_bf16 v[96:99], v[208:211], v[16:19], v[96:99]
    v_mfma_f32_16x16x32_bf16 v[100:103], v[212:215], v[16:19], v[100:103]
    v_mfma_f32_16x16x32_bf16 v[104:107], v[216:219], v[16:19], v[104:107]
    v_mfma_f32_16x16x32_bf16 v[108:111], v[220:223], v[16:19], v[108:111]
    s_waitcnt vmcnt(0)
    v_mfma_f32_16x16x32_bf16 v[112:115], v[208:211], v[20:23], v[112:115]
    v_mfma_f32_16x16x32_bf16 v[116:119], v[212:215], v[20:23], v[116:119]
    v_mfma_f32_16x16x32_bf16 v[120:123], v[216:219], v[20:23], v[120:123]
    v_mfma_f32_16x16x32_bf16 v[124:127], v[220:223], v[20:23], v[124:127]
    v_lshlrev_b32 v13, 4, v0
    v_add_u32 v8, s76, v13
    s_lshl_b32 s84, s7, 11
    s_and_b32 s84, s84, 0x1fff
    s_cmp_ge_u32 s7, 4
    s_cselect_b32 s85, 40960, 0
    s_add_u32 s85, s85, s84
    v_add_u32 v10, s85, v13
    v_add_u32 v11, 81920, v10
    s_nop 3
    ds_write_b128 v8, v[64:67] offset:0
    ds_write_b128 v8, v[68:71] offset:1024
    ds_write_b128 v8, v[72:75] offset:2048
    ds_write_b128 v8, v[76:79] offset:3072
    ds_write_b128 v8, v[80:83] offset:4096
    ds_write_b128 v8, v[84:87] offset:5120
    ds_write_b128 v8, v[88:91] offset:6144
    ds_write_b128 v8, v[92:95] offset:7168
    ds_write_b128 v8, v[96:99] offset:40960
    ds_write_b128 v8, v[100:103] offset:41984
    ds_write_b128 v8, v[104:107] offset:43008
    ds_write_b128 v8, v[108:111] offset:44032
    ds_write_b128 v8, v[112:115] offset:45056
    ds_write_b128 v8, v[116:119] offset:46080
    ds_write_b128 v8, v[120:123] offset:47104
    ds_write_b128 v8, v[124:127] offset:48128
    s_lshl_b32 s84, s5, 18
    s_lshr_b32 s85, s7, 1
    s_lshl_b32 s85, s85, 16
    s_add_u32 s84, s84, s85
    s_lshl_b32 s85, s3, 11
    s_add_u32 s84, s84, s85
    s_lshl_b32 s85, s4, 9
    s_add_u32 s84, s84, s85
    s_lshl_b32 s85, s6, 7
    s_add_u32 s84, s84, s85
    s_and_b32 s85, s7, 1
    s_lshl_b32 s85, s85, 6
    s_add_u32 s84, s84, s85
    v_and_b32 v9, 15, v0
    v_lshlrev_b32 v9, 12, v9
    v_bfe_u32 v12, v0, 4, 1
    v_lshl_add_u32 v9, v12, 5, v9
    v_lshrrev_b32 v12, 5, v0
    v_lshl_add_u32 v9, v12, 4, v9
    s_waitcnt lgkmcnt(0)
    s_barrier
    ds_read_b128 v[128:131], v11 offset:0
    ds_read_b128 v[132:135], v11 offset:1024
    ds_read_b128 v[136:139], v11 offset:10240
    ds_read_b128 v[140:143], v11 offset:11264
    ds_read_b128 v[144:147], v11 offset:20480
    ds_read_b128 v[148:151], v11 offset:21504
    ds_read_b128 v[152:155], v11 offset:30720
    ds_read_b128 v[156:159], v11 offset:31744
    ds_read_b128 v[160:163], v10 offset:0
    ds_read_b128 v[164:167], v10 offset:1024
    ds_read_b128 v[168:171], v10 offset:10240
    ds_read_b128 v[172:175], v10 offset:11264
    ds_read_b128 v[176:179], v10 offset:20480
    ds_read_b128 v[180:183], v10 offset:21504
    ds_read_b128 v[184:187], v10 offset:30720
    ds_read_b128 v[188:191], v10 offset:31744
    s_waitcnt lgkmcnt(12)
    v_pk_add_f32 v[128:129], v[128:129], v[136:137]
    v_pk_add_f32 v[130:131], v[130:131], v[138:139]
    v_pk_add_f32 v[132:133], v[132:133], v[140:141]
    v_pk_add_f32 v[134:135], v[134:135], v[142:143]
    s_waitcnt lgkmcnt(10)
    v_pk_add_f32 v[128:129], v[128:129], v[144:145]
    v_pk_add_f32 v[130:131], v[130:131], v[146:147]
    v_pk_add_f32 v[132:133], v[132:133], v[148:149]
    v_pk_add_f32 v[134:135], v[134:135], v[150:151]
    s_waitcnt lgkmcnt(8)
    v_pk_add_f32 v[128:129], v[128:129], v[152:153]
    v_pk_add_f32 v[130:131], v[130:131], v[154:155]
    v_pk_add_f32 v[132:133], v[132:133], v[156:157]
    v_pk_add_f32 v[134:135], v[134:135], v[158:159]
    s_waitcnt lgkmcnt(6)
    v_pk_add_f32 v[128:129], v[128:129], v[160:161]
    v_pk_add_f32 v[130:131], v[130:131], v[162:163]
    v_pk_add_f32 v[132:133], v[132:133], v[164:165]
    v_pk_add_f32 v[134:135], v[134:135], v[166:167]
    s_waitcnt lgkmcnt(4)
    v_pk_add_f32 v[128:129], v[128:129], v[168:169]
    v_pk_add_f32 v[130:131], v[130:131], v[170:171]
    v_pk_add_f32 v[132:133], v[132:133], v[172:173]
    v_pk_add_f32 v[134:135], v[134:135], v[174:175]
    s_waitcnt lgkmcnt(2)
    v_pk_add_f32 v[128:129], v[128:129], v[176:177]
    v_pk_add_f32 v[130:131], v[130:131], v[178:179]
    v_pk_add_f32 v[132:133], v[132:133], v[180:181]
    v_pk_add_f32 v[134:135], v[134:135], v[182:183]
    s_waitcnt lgkmcnt(0)
    v_pk_add_f32 v[128:129], v[128:129], v[184:185]
    v_pk_add_f32 v[130:131], v[130:131], v[186:187]
    v_pk_add_f32 v[132:133], v[132:133], v[188:189]
    v_pk_add_f32 v[134:135], v[134:135], v[190:191]
    v_cvt_pk_bf16_f32 v192, v128, v129
    v_cvt_pk_bf16_f32 v193, v130, v131
    v_cvt_pk_bf16_f32 v194, v132, v133
    v_cvt_pk_bf16_f32 v195, v134, v135
    s_nop 1
    v_permlane16_swap_b32 v192, v194
    v_permlane16_swap_b32 v193, v195
    buffer_store_dwordx4 v[192:195], v9, s[68:71], s84 offen
L_end:
    s_endpgm
L_init:
    s_waitcnt vmcnt(0)
    v_mov_b32 v1, 1
    v_mov_b32 v7, 0
    s_lshl_b32 s13, s43, 4
    s_mov_b64 exec, 1
    buffer_atomic_add v1, v7, s[72:75], s13 offen sc1
    s_mov_b64 exec, -1
    s_branch L_init_ret
L_stub0:
    s_call_b64 s[18:19], L_slow1
    s_branch L_ret0
L_stub1:
    s_call_b64 s[18:19], L_slow0
    s_branch L_ret1
L_stub2:
    s_call_b64 s[18:19], L_slow1
    s_branch L_ret2
L_stub3:
    s_call_b64 s[18:19], L_slow0
    s_branch L_ret3
L_stub4:
    s_call_b64 s[18:19], L_slow1
    s_branch L_ret4
L_stub5:
    s_call_b64 s[18:19], L_slow0
    s_branch L_ret5
L_stub6:
    s_call_b64 s[18:19], L_slow1
    s_branch L_ret6
L_stub7:
    s_call_b64 s[18:19], L_slow0
    s_branch L_ret7
L_stub8:
    s_call_b64 s[18:19], L_slow1
    s_branch L_ret8
L_stub9:
    s_call_b64 s[18:19], L_slow0
    s_branch L_ret9
L_stub10:
    s_call_b64 s[18:19], L_slow1
    s_branch L_ret10
L_stub11:
    s_call_b64 s[18:19], L_slow0
    s_branch L_ret11
L_stub12:
    s_call_b64 s[18:19], L_slow1
    s_branch L_ret12
L_stub13:
    s_call_b64 s[18:19], L_slow0
    s_branch L_ret13
L_stub14:
    s_call_b64 s[18:19], L_slow1
    s_branch L_ret14
L_slow0:
    s_nop 15
    v_mov_b32 v248, v254
    s_nop 1
    v_permlane32_swap_b32 v248, v254
    v_max_f32 v254, v254, v248
    v_max_f32 v254, 0, v254
    v_exp_f32 v248, -v254
    v_sub_f32 v128, v128, v254
    v_sub_f32 v129, v129, v254
    v_sub_f32 v130, v130, v254
    v_sub_f32 v131, v131, v254
    v_sub_f32 v132, v132, v254
    v_sub_f32 v133, v133, v254
    v_sub_f32 v134, v134, v254
    v_sub_f32 v135, v135, v254
    v_sub_f32 v136, v136, v254
    v_sub_f32 v137, v137, v254
    v_sub_f32 v138, v138, v254
    v_sub_f32 v139, v139, v254
    v_sub_f32 v140, v140, v254
    v_sub_f32 v141, v141, v254
    v_sub_f32 v142, v142, v254
    v_sub_f32 v143, v143, v254
    v_sub_f32 v160, v160, v254
    v_sub_f32 v161, v161, v254
    v_sub_f32 v162, v162, v254
    v_sub_f32 v163, v163, v254
    v_sub_f32 v164, v164, v254
    v_sub_f32 v165, v165, v254
    v_sub_f32 v166, v166, v254
    v_sub_f32 v167, v167, v254
    v_sub_f32 v168, v168, v254
    v_sub_f32 v169, v169, v254
    v_sub_f32 v170, v170, v254
    v_sub_f32 v171, v171, v254
    v_sub_f32 v172, v172, v254
    v_sub_f32 v173, v173, v254
    v_sub_f32 v174, v174, v254
    v_sub_f32 v175, v175, v254
    v_mul_f32 v64, v64, v248
    v_mul_f32 v65, v65, v248
    v_mul_f32 v66, v66, v248
    v_mul_f32 v67, v67, v248
    v_mul_f32 v68, v68, v248
    v_mul_f32 v69, v69, v248
    v_mul_f32 v70, v70, v248
    v_mul_f32 v71, v71, v248
    v_mul_f32 v72, v72, v248
    v_mul_f32 v73, v73, v248
    v_mul_f32 v74, v74, v248
    v_mul_f32 v75, v75, v248
    v_mul_f32 v76, v76, v248
    v_mul_f32 v77, v77, v248
    v_mul_f32 v78, v78, v248
    v_mul_f32 v79, v79, v248
    v_mul_f32 v80, v80, v248
    v_mul_f32 v81, v81, v248
    v_mul_f32 v82, v82, v248
    v_mul_f32 v83, v83, v248
    v_mul_f32 v84, v84, v248
    v_mul_f32 v85, v85, v248
    v_mul_f32 v86, v86, v248
    v_mul_f32 v87, v87, v248
    v_mul_f32 v88, v88, v248
    v_mul_f32 v89, v89, v248
    v_mul_f32 v90, v90, v248
    v_mul_f32 v91, v91, v248
    v_mul_f32 v92, v92, v248
    v_mul_f32 v93, v93, v248
    v_mul_f32 v94, v94, v248
    v_mul_f32 v95, v95, v248
    v_mul_f32 v96, v96, v248
    v_mul_f32 v97, v97, v248
    v_mul_f32 v98, v98, v248
    v_mul_f32 v99, v99, v248
    v_mul_f32 v100, v100, v248
    v_mul_f32 v101, v101, v248
    v_mul_f32 v102, v102, v248
    v_mul_f32 v103, v103, v248
    v_mul_f32 v104, v104, v248
    v_mul_f32 v105, v105, v248
    v_mul_f32 v106, v106, v248
    v_mul_f32 v107, v107, v248
    v_mul_f32 v108, v108, v248
    v_mul_f32 v109, v109, v248
    v_mul_f32 v110, v110, v248
    v_mul_f32 v111, v111, v248
    v_mul_f32 v112, v112, v248
    v_mul_f32 v113, v113, v248
    v_mul_f32 v114, v114, v248
    v_mul_f32 v115, v115, v248
    v_mul_f32 v116, v116, v248
    v_mul_f32 v117, v117, v248
    v_mul_f32 v118, v118, v248
    v_mul_f32 v119, v119, v248
    v_mul_f32 v120, v120, v248
    v_mul_f32 v121, v121, v248
    v_mul_f32 v122, v122, v248
    v_mul_f32 v123, v123, v248
    v_mul_f32 v124, v124, v248
    v_mul_f32 v125, v125, v248
    v_mul_f32 v126, v126, v248
    v_mul_f32 v127, v127, v248
    v_mul_f32 v252, v252, v248
    v_mul_f32 v253, v253, v248
    s_nop 3
    s_setpc_b64 s[18:19]
L_slow1:
    s_nop 15
    v_mov_b32 v248, v254
    s_nop 1
    v_permlane32_swap_b32 v248, v254
    v_max_f32 v254, v254, v248
    v_max_f32 v254, 0, v254
    v_exp_f32 v248, -v254
    v_sub_f32 v144, v144, v254
    v_sub_f32 v145, v145, v254
    v_sub_f32 v146, v146, v254
    v_sub_f32 v147, v147, v254
    v_sub_f32 v148, v148, v254
    v_sub_f32 v149, v149, v254
    v_sub_f32 v150, v150, v254
    v_sub_f32 v151, v151, v254
    v_sub_f32 v152, v152, v254
    v_sub_f32 v153, v153, v254
    v_sub_f32 v154, v154, v254
    v_sub_f32 v155, v155, v254
    v_sub_f32 v156, v156, v254
    v_sub_f32 v157, v157, v254
    v_sub_f32 v158, v158, v254
    v_sub_f32 v159, v159, v254
    v_sub_f32 v160, v160, v254
    v_sub_f32 v161, v161, v254
    v_sub_f32 v162, v162, v254
    v_sub_f32 v163, v163, v254
    v_sub_f32 v164, v164, v254
    v_sub_f32 v165, v165, v254
    v_sub_f32 v166, v166, v254
    v_sub_f32 v167, v167, v254
    v_sub_f32 v168, v168, v254
    v_sub_f32 v169, v169, v254
    v_sub_f32 v170, v170, v254
    v_sub_f32 v171, v171, v254
    v_sub_f32 v172, v172, v254
    v_sub_f32 v173, v173, v254
    v_sub_f32 v174, v174, v254
    v_sub_f32 v175, v175, v254
    v_mul_f32 v64, v64, v248
    v_mul_f32 v65, v65, v248
    v_mul_f32 v66, v66, v248
    v_mul_f32 v67, v67, v248
    v_mul_f32 v68, v68, v248
    v_mul_f32 v69, v69, v248
    v_mul_f32 v70, v70, v248
    v_mul_f32 v71, v71, v248
    v_mul_f32 v72, v72, v248
    v_mul_f32 v73, v73, v248
    v_mul_f32 v74, v74, v248
    v_mul_f32 v75, v75, v248
    v_mul_f32 v76, v76, v248
    v_mul_f32 v77, v77, v248
    v_mul_f32 v78, v78, v248
    v_mul_f32 v79, v79, v248
    v_mul_f32 v80, v80, v248
    v_mul_f32 v81, v81, v248
    v_mul_f32 v82, v82, v248
    v_mul_f32 v83, v83, v248
    v_mul_f32 v84, v84, v248
    v_mul_f32 v85, v85, v248
    v_mul_f32 v86, v86, v248
    v_mul_f32 v87, v87, v248
    v_mul_f32 v88, v88, v248
    v_mul_f32 v89, v89, v248
    v_mul_f32 v90, v90, v248
    v_mul_f32 v91, v91, v248
    v_mul_f32 v92, v92, v248
    v_mul_f32 v93, v93, v248
    v_mul_f32 v94, v94, v248
    v_mul_f32 v95, v95, v248
    v_mul_f32 v96, v96, v248
    v_mul_f32 v97, v97, v248
    v_mul_f32 v98, v98, v248
    v_mul_f32 v99, v99, v248
    v_mul_f32 v100, v100, v248
    v_mul_f32 v101, v101, v248
    v_mul_f32 v102, v102, v248
    v_mul_f32 v103, v103, v248
    v_mul_f32 v104, v104, v248
    v_mul_f32 v105, v105, v248
    v_mul_f32 v106, v106, v248
    v_mul_f32 v107, v107, v248
    v_mul_f32 v108, v108, v248
    v_mul_f32 v109, v109, v248
    v_mul_f32 v110, v110, v248
    v_mul_f32 v111, v111, v248
    v_mul_f32 v112, v112, v248
    v_mul_f32 v113, v113, v248
    v_mul_f32 v114, v114, v248
    v_mul_f32 v115, v115, v248
    v_mul_f32 v116, v116, v248
    v_mul_f32 v117, v117, v248
    v_mul_f32 v118, v118, v248
    v_mul_f32 v119, v119, v248
    v_mul_f32 v120, v120, v248
    v_mul_f32 v121, v121, v248
    v_mul_f32 v122, v122, v248
    v_mul_f32 v123, v123, v248
    v_mul_f32 v124, v124, v248
    v_mul_f32 v125, v125, v248
    v_mul_f32 v126, v126, v248
    v_mul_f32 v127, v127, v248
    v_mul_f32 v252, v252, v248
    v_mul_f32 v253, v253, v248
    s_nop 3
    s_setpc_b64 s[18:19]
L_codeend:
.section .rodata,"a"
.p2align 6
.amdhsa_kernel concat_heads__gqa_block_cached__gqa_block_cached__near_ridge_kernel
  .amdhsa_next_free_vgpr 256
  .amdhsa_next_free_sgpr 102
  .amdhsa_accum_offset 256
  .amdhsa_group_segment_fixed_size 0
  .amdhsa_kernarg_size 104
  .amdhsa_user_sgpr_count 2
  .amdhsa_user_sgpr_kernarg_segment_ptr 1
  .amdhsa_system_sgpr_workgroup_id_x 1
.end_amdhsa_kernel
```
